```python
import torch

def _softmax(x, axis=-1):
    return torch.softmax(x, dim=axis)
def _gelu(x):
    return torch.nn.functional.gelu(x, approximate="tanh")
def _silu(x):
    return torch.nn.functional.silu(x)
def _sigmoid(x):
    return torch.sigmoid(x)
def _layernorm(x, axis=-1, eps=1e-5):
    m = x.mean(dim=axis, keepdim=True)
    v = x.var(dim=axis, keepdim=True, unbiased=False)
    return (x - m) / torch.sqrt(v + eps)
def _scatter_add(tgt, idx, src, axis=0):
    return tgt.clone().index_add_(axis, idx, src)
def _segment_sum(src, seg, n):
    out = torch.zeros((n,) + src.shape[1:], dtype=src.dtype)
    return out.index_add_(0, seg, src)
def _pad(x, pw):
    flat = tuple(v for pair in reversed(pw) for v in pair)
    return torch.nn.functional.pad(x, flat)

kernel_name = 'concat_heads__gqa_block_cached__mha_block_cached__near_ridge'

def setup_inputs():

    _w = (lambda a: (lambda t: t.to(torch.bfloat16) if t.is_floating_point() else t)(torch.as_tensor(a)))
    def _A_setup():
        B, Sq, D = 16, 32, 512
        Hq, Hkv, Sk, Dh = 32, 8, 32, 128
        assert Hq % Hkv == 0, (Hq, Hkv)
        return {
            "x": _w((lambda *s: torch.randn(*s, dtype=torch.bfloat16) * 0.8)(B, Sq, D)),
            "k_cache": _w((lambda *s: torch.randn(*s, dtype=torch.bfloat16) * 0.8)(B, Hkv, Sk, Dh)),
            "v_cache": _w((lambda *s: torch.randn(*s, dtype=torch.bfloat16) * 0.05)(B, Hkv, Sk, Dh)),
            "wq": _w((lambda *s: torch.randn(*s, dtype=torch.bfloat16) * 0.8)(D, Hq * Dh) * (D ** -0.5)),
            "wo": _w((lambda *s: torch.randn(*s, dtype=torch.bfloat16) * 0.05)(Hq * Dh, D) * ((Hq * Dh) ** -0.5)),
        }
    _A_in = _A_setup()

    def _B_setup():
        B, Sq, D = 16, 32, 512
        H, Sk, Dh = 32, 32, 128
        return {
            "x": _w((lambda *s: torch.randn(*s, dtype=torch.bfloat16) * 0.8)(B, Sq, D)),
            "k_cache": _w((lambda *s: torch.randn(*s, dtype=torch.bfloat16) * 0.8)(B, H, Sk, Dh)),
            "v_cache": _w((lambda *s: torch.randn(*s, dtype=torch.bfloat16) * 0.05)(B, H, Sk, Dh)),
            "wq": _w((lambda *s: torch.randn(*s, dtype=torch.bfloat16) * 0.8)(D, H * Dh) * (D ** -0.5)),
            "wo": _w((lambda *s: torch.randn(*s, dtype=torch.bfloat16) * 0.05)(H * Dh, D) * ((H * Dh) ** -0.5)),
        }
    _B_in = _B_setup()

    return {
        "A_x": _A_in["x"],
        "A_k_cache": _A_in["k_cache"],
        "A_v_cache": _A_in["v_cache"],
        "A_wq": _A_in["wq"],
        "A_wo": _A_in["wo"],
        "B_x": _B_in["x"],
        "B_k_cache": _B_in["k_cache"],
        "B_v_cache": _B_in["v_cache"],
        "B_wq": _B_in["wq"],
        "B_wo": _B_in["wo"],
    }

def reference(A_x, A_k_cache, A_v_cache, A_wq, A_wo, B_x, B_k_cache, B_v_cache, B_wq, B_wo):
    def _A_ref(x, k_cache, v_cache, wq, wo):
        B, Sq, D = x.shape
        Hq, Dh = 32, 128
        Hkv = k_cache.shape[1]
        rep = Hq // Hkv
        q = (lambda x, *d: x.permute(*d))((x @ wq).reshape(B, Sq, Hq, Dh), 0, 2, 1, 3)
        k = (lambda x, n, axis: torch.repeat_interleave(x, n, dim=axis))(k_cache, rep, axis=1)
        v = (lambda x, n, axis: torch.repeat_interleave(x, n, dim=axis))(v_cache, rep, axis=1)
        scores = torch.einsum("bhqd,bhkd->bhqk", q, k) * (Dh ** -0.5)
        p = _softmax(scores, axis=-1)
        o = torch.einsum("bhqk,bhkd->bhqd", p, v)
        return (lambda x, *d: x.permute(*d))(o, 0, 2, 1, 3).reshape(B, Sq, Hq * Dh) @ wo

    def _B_ref(x, k_cache, v_cache, wq, wo):
        B, Sq, D = x.shape
        H, Dh = 32, 128
        q = (lambda x, *d: x.permute(*d))((x @ wq).reshape(B, Sq, H, Dh), 0, 2, 1, 3)
        scores = torch.einsum("bhqd,bhkd->bhqk", q, k_cache) * (Dh ** -0.5)
        p = _softmax(scores, axis=-1)
        o = torch.einsum("bhqk,bhkd->bhqd", p, v_cache)
        return (lambda x, *d: x.permute(*d))(o, 0, 2, 1, 3).reshape(B, Sq, H * Dh) @ wo

    a = _A_ref(A_x, A_k_cache, A_v_cache, A_wq, A_wo)
    b = _B_ref(B_x, B_k_cache, B_v_cache, B_wq, B_wo)
    return torch.concatenate([a, b], axis=-1)
```

```asm
; @launch grid=(256,1,1) block=(512,1,1) lds=163840
.amdgcn_target "amdgcn-amd-amdhsa--gfx950"
.text

.globl concat_heads__gqa_block_cached__mha_block_cached__near_ridge_kernel
.p2align 8
.type concat_heads__gqa_block_cached__mha_block_cached__near_ridge_kernel,@function
concat_heads__gqa_block_cached__mha_block_cached__near_ridge_kernel:
    s_cmp_ge_u32 s2, 256
    s_cbranch_scc1 L_end
    s_load_dwordx16 s[4:19], s[0:1], 0
    s_load_dwordx8 s[20:27], s[0:1], 64
    s_load_dwordx2 s[28:29], s[0:1], 96
    v_lshrrev_b32 v1, 6, v0
    v_and_b32 v0, 63, v0
    s_and_b32 s65, s2, 3
    v_readfirstlane_b32 s68, v1
    s_nop 0
    s_lshr_b32 s74, s68, 2
    s_and_b32 s68, s68, 3
    s_bfe_u32 s64, s2, 0x10002
    s_bfe_u32 s66, s2, 0x30003
    s_bfe_u32 s67, s2, 0x20006
    s_lshl_b32 s70, s65, 3
    s_add_u32 s70, s70, s66
    s_lshl_b32 s69, s67, 2
    s_add_u32 s69, s69, s68
    s_lshl_b32 s81, s68, 12
    s_add_u32 s82, s81, 16384
    s_lshl_b32 s83, s68, 13
    v_lshrrev_b32 v32, 4, v0
    v_and_b32 v33, 15, v0
    v_lshlrev_b32 v34, 2, v32
    v_xor_b32 v34, v34, v33
    v_lshlrev_b32 v34, 4, v34
    v_lshl_add_u32 v4, v32, 13, v34
    s_lshl_b32 s71, s68, 17
    v_add_u32 v4, s71, v4
    v_add_u32 v5, 31744, v4
    v_add_u32 v6, 63488, v4
    v_add_u32 v7, 95232, v4
    v_lshl_add_u32 v16, v32, 8, v34
    v_xor_b32 v34, v32, v33
    v_lshlrev_b32 v34, 4, v34
    v_lshl_add_u32 v12, v32, 8, v34
    v_xor_b32 v13, 64, v12
    v_xor_b32 v14, 128, v12
    v_xor_b32 v15, 192, v12
    v_lshrrev_b32 v32, 3, v0
    v_and_b32 v33, 7, v0
    v_lshrrev_b32 v34, 1, v32
    v_xor_b32 v34, v34, v33
    v_lshlrev_b32 v34, 4, v34
    v_lshl_add_u32 v8, v32, 10, v34
    v_xor_b32 v9, 64, v8
    v_add_u32 v10, 14336, v8
    v_add_u32 v11, 21504, v9
    v_add_u32 v9, 7168, v9
    s_lshl_b32 s75, s70, 8
    s_lshl_b32 s76, s69, 15
    s_lshr_b32 s71, s70, 2
    s_lshl_b32 s72, s69, 3
    s_add_u32 s71, s71, s72
    s_lshl_b32 s72, s69, 5
    s_add_u32 s72, s72, s70
    s_cmp_eq_u32 s64, 0
    s_cselect_b32 s77, s71, s72
    s_lshl_b32 s77, s77, 13
    s_mov_b32 s84, s77
    v_lshrrev_b32 v32, 5, v0
    v_bfe_u32 v33, v0, 2, 2
    v_bfe_u32 v34, v0, 4, 1
    v_and_b32 v35, 3, v0
    v_and_b32 v24, 1, v0
    v_lshlrev_b32 v24, 4, v24
    v_and_b32 v36, 2, v0
    v_lshl_add_u32 v24, v36, 2, v24
    v_lshl_add_u32 v24, v34, 5, v24
    v_lshl_add_u32 v36, v32, 3, v33
    v_lshl_add_u32 v24, v36, 8, v24
    v_lshl_add_u32 v24, v33, 6, v24
    v_xor_b32 v25, 64, v24
    v_xor_b32 v26, 128, v24
    v_xor_b32 v27, 192, v24
    v_and_b32 v36, 31, v0
    v_bfe_u32 v37, v0, 1, 3
    v_xor_b32 v37, v37, v32
    v_lshlrev_b32 v37, 4, v37
    v_lshl_add_u32 v28, v36, 7, v37
    v_add_u32 v28, s82, v28
    v_xor_b32 v29, 32, v28
    v_xor_b32 v30, 64, v28
    v_xor_b32 v31, 96, v28
    s_and_b32 s85, s66, 3
    s_lshr_b32 s3, s70, 2
    v_lshrrev_b32 v32, 4, v0
    v_and_b32 v33, 15, v0
    v_lshlrev_b32 v34, 2, v32
    v_xor_b32 v34, v34, v33
    v_lshlrev_b32 v34, 4, v34
    v_lshl_add_u32 v20, v32, 10, v34
    s_lshl_b32 s71, s68, 15
    v_add_u32 v20, s71, v20
    v_add_u32 v21, 3072, v20
    v_add_u32 v22, 6144, v20
    v_add_u32 v23, 9216, v20
    v_lshrrev_b32 v32, 5, v0
    v_and_b32 v33, 15, v0
    v_xor_b32 v33, v33, v32
    v_lshlrev_b32 v33, 4, v33
    v_and_b32 v34, 31, v0
    v_lshl_add_u32 v18, v34, 8, v33
    s_add_u32 s71, s83, 98304
    v_add_u32 v18, s71, v18
    v_lshlrev_b32 v250, 11, v34
    v_lshl_add_u32 v250, v32, 4, v250
    v_lshrrev_b32 v32, 5, v0
    v_bfe_u32 v33, v0, 2, 2
    v_bfe_u32 v34, v0, 4, 1
    v_and_b32 v35, 3, v0
    v_lshl_add_u32 v37, v32, 2, v33
    v_lshlrev_b32 v37, 8, v37
    v_lshl_add_u32 v37, v33, 6, v37
    v_lshl_add_u32 v19, v35, 3, v37
    v_lshl_add_u32 v19, v34, 5, v19
    s_add_u32 s71, s83, 131072
    v_add_u32 v19, s71, v19
    v_and_b32 v240, 1, v0
    v_lshlrev_b32 v240, 4, v240
    v_and_b32 v36, 2, v0
    v_lshl_add_u32 v240, v36, 2, v240
    v_lshl_add_u32 v240, v34, 5, v240
    v_add_u32 v240, v240, v37
    v_xor_b32 v241, 64, v240
    v_xor_b32 v242, 128, v240
    v_xor_b32 v243, 192, v240
    s_and_b32 s71, s2, 0xe7
    s_lshl_b32 s71, s71, 8
    s_lshl_b32 s72, s68, 4
    s_add_u32 s71, s71, s72
    s_lshl_b32 s73, s85, 2
    s_add_u32 s71, s71, s73
    v_and_b32 v32, 3, v0
    v_lshlrev_b32 v244, 11, v32
    v_add_u32 v244, s71, v244
    s_lshl_b32 s71, s2, 8
    s_add_u32 s72, s71, s72
    v_lshlrev_b32 v246, 2, v32
    v_add_u32 v246, s72, v246
    v_and_b32 v32, 7, v0
    v_lshlrev_b32 v247, 2, v32
    s_add_u32 s72, s71, 128
    v_add_u32 v247, s72, v247
    s_and_b32 s71, s2, 0xdc
    s_or_b32 s71, s71, s68
    s_lshl_b32 s71, s71, 8
    s_lshl_b32 s72, s3, 2
    s_add_u32 s71, s71, s72
    s_add_u32 s71, s71, 128
    v_and_b32 v32, 1, v0
    v_lshlrev_b32 v245, 13, v32
    v_add_u32 v245, s71, v245
    v_mov_b32 v249, 1
    s_lshl_b32 s30, s67, 1
    s_add_u32 s30, s30, s64
    s_lshl_b32 s30, s30, 5
    v_and_b32 v32, 7, v0
    v_lshl_add_u32 v254, v32, 2, s30
    s_lshl2_add_u32 s30, s3, s30
    v_mov_b32 v251, s30
    v_add_u32 v240, 0x10000, v240
    v_add_u32 v241, 0x10000, v241
    v_add_u32 v242, 0x10000, v242
    v_add_u32 v243, 0x10000, v243
    v_lshlrev_b32 v17, 4, v0
    v_lshlrev_b32 v1, 2, v0
    v_mov_b32 v2, 0
    s_lshl_b32 s73, s2, 8
    s_add_u32 s73, s73, 0x1000000
    s_cmp_eq_u32 s74, 1
    s_cbranch_scc1 L_helper
    s_waitcnt lgkmcnt(0)
    s_cmp_eq_u32 s64, 0
    s_cselect_b64 s[36:37], s[10:11], s[20:21]
    s_mov_b32 s38, 0x400000
    s_mov_b32 s39, 0x20000
    s_cselect_b64 s[32:33], s[4:5], s[14:15]
    s_mov_b32 s34, 0x80000
    s_mov_b32 s35, 0x20000
    s_add_u32 m0, s81, 0
    s_nop 0
    buffer_load_dwordx4 v4, s[36:39], s75 offen lds
    buffer_load_dwordx4 v5, s[36:39], s75 offen offset:1024 lds
    buffer_load_dwordx4 v6, s[36:39], s75 offen offset:2048 lds
    buffer_load_dwordx4 v7, s[36:39], s75 offen offset:3072 lds
    s_add_u32 s75, s75, 524288
    s_bitset0_b32 s75, 22
    s_add_u32 m0, s82, 0
    s_nop 0
    buffer_load_dwordx4 v8, s[32:35], s76 offen lds
    buffer_load_dwordx4 v9, s[32:35], s76 offen offset:1024 lds
    buffer_load_dwordx4 v10, s[32:35], s76 offen offset:2048 lds
    buffer_load_dwordx4 v11, s[32:35], s76 offen offset:3072 lds
    s_add_u32 s76, s76, 128
    s_bitset0_b32 s76, 10
    s_cmp_eq_u32 s64, 0
    s_mov_b64 s[52:53], s[28:29]
    s_mov_b32 s54, 0x2000000
    s_mov_b32 s55, 0x20000
    s_mov_b64 s[56:57], s[24:25]
    s_mov_b32 s58, 0x100000
    s_mov_b32 s59, 0x20000
    s_mov_b64 s[60:61], s[26:27]
    s_mov_b32 s62, 0x100
    s_mov_b32 s63, 0x20000
    s_add_u32 m0, s81, 32768
    s_nop 0
    buffer_load_dwordx4 v4, s[36:39], s75 offen lds
    buffer_load_dwordx4 v5, s[36:39], s75 offen offset:1024 lds
    buffer_load_dwordx4 v6, s[36:39], s75 offen offset:2048 lds
    buffer_load_dwordx4 v7, s[36:39], s75 offen offset:3072 lds
    s_add_u32 s75, s75, 524288
    s_bitset0_b32 s75, 22
    s_add_u32 m0, s82, 32768
    s_nop 0
    buffer_load_dwordx4 v8, s[32:35], s76 offen lds
    buffer_load_dwordx4 v9, s[32:35], s76 offen offset:1024 lds
    buffer_load_dwordx4 v10, s[32:35], s76 offen offset:2048 lds
    buffer_load_dwordx4 v11, s[32:35], s76 offen offset:3072 lds
    s_add_u32 s76, s76, 128
    s_bitset0_b32 s76, 10
    s_add_u32 m0, s81, 65536
    s_nop 0
    buffer_load_dwordx4 v4, s[36:39], s75 offen lds
    buffer_load_dwordx4 v5, s[36:39], s75 offen offset:1024 lds
    buffer_load_dwordx4 v6, s[36:39], s75 offen offset:2048 lds
    buffer_load_dwordx4 v7, s[36:39], s75 offen offset:3072 lds
    s_add_u32 s75, s75, 524288
    s_bitset0_b32 s75, 22
    s_add_u32 m0, s82, 65536
    s_nop 0
    buffer_load_dwordx4 v8, s[32:35], s76 offen lds
    buffer_load_dwordx4 v9, s[32:35], s76 offen offset:1024 lds
    buffer_load_dwordx4 v10, s[32:35], s76 offen offset:2048 lds
    buffer_load_dwordx4 v11, s[32:35], s76 offen offset:3072 lds
    s_add_u32 s76, s76, 128
    s_bitset0_b32 s76, 10
    s_mov_b32 s79, 0x1000000
    s_getreg_b32 s5, hwreg(HW_REG_XCC_ID, 0, 3)
    s_lshl_b32 s5, s5, 2
    s_lshl_b32 s5, 1, s5
    v_mov_b32 v253, s5
    s_lshl_b32 s5, s5, 2
    s_mov_b32 s6, 0x11111111
    s_cmp_eq_u32 s67, 3
    s_cselect_b32 s71, 0, s67
    s_add_u32 s72, s71, 1
    s_cmp_gt_u32 s72, 3
    s_cselect_b32 s14, 3, 0
    s_sub_u32 s72, s72, s14
    s_add_u32 s72, s72, s85
    s_and_b32 s15, s72, 3
    s_add_u32 s72, s71, 2
    s_cmp_gt_u32 s72, 3
    s_cselect_b32 s14, 3, 0
    s_sub_u32 s72, s72, s14
    s_add_u32 s72, s72, s85
    s_and_b32 s16, s72, 3
    s_add_u32 s72, s71, 3
    s_cmp_gt_u32 s72, 3
    s_cselect_b32 s14, 3, 0
    s_sub_u32 s72, s72, s14
    s_add_u32 s72, s72, s85
    s_and_b32 s17, s72, 3
    s_lshl2_add_u32 s71, s64, s67
    s_lshl2_add_u32 s71, s71, s85
    s_lshl2_add_u32 s72, s71, s68
    s_lshl_b32 s72, s72, 6
    s_add_u32 s72, s72, s3
    s_lshl_b32 s72, s72, 10
    s_add_u32 s80, s72, 0x800000
    s_mov_b32 s4, s80
    v_mov_b32 v176, -1
    v_mov_b32 v177, -1
    v_mov_b32 v178, -1
    v_mov_b32 v179, -1
    s_waitcnt vmcnt(16)
    s_barrier
    ds_read_b128 v[72:75], v28
    ds_read_b64_tr_b16 v[40:41], v24 offset:0
    ds_read_b64_tr_b16 v[42:43], v24 offset:1024
    ds_read_b64_tr_b16 v[44:45], v25 offset:0
    ds_read_b64_tr_b16 v[46:47], v25 offset:1024
    ds_read_b64_tr_b16 v[48:49], v26 offset:0
    ds_read_b64_tr_b16 v[50:51], v26 offset:1024
    ds_read_b64_tr_b16 v[52:53], v27 offset:0
    ds_read_b64_tr_b16 v[54:55], v27 offset:1024
    s_waitcnt lgkmcnt(6)
    v_mfma_f32_32x32x16_bf16 v[80:95], v[40:43], v[72:75], 0
    ds_read_b128 v[76:79], v29
    ds_read_b64_tr_b16 v[56:57], v24 offset:4096
    ds_read_b64_tr_b16 v[58:59], v24 offset:5120
    ds_read_b64_tr_b16 v[60:61], v25 offset:4096
    s_waitcnt lgkmcnt(8)
    v_mfma_f32_32x32x16_bf16 v[96:111], v[44:47], v[72:75], 0
    ds_read_b64_tr_b16 v[62:63], v25 offset:5120
    ds_read_b64_tr_b16 v[64:65], v26 offset:4096
    ds_read_b64_tr_b16 v[66:67], v26 offset:5120
    s_waitcnt lgkmcnt(9)
    v_mfma_f32_32x32x16_bf16 v[112:127], v[48:51], v[72:75], 0
    ds_read_b64_tr_b16 v[68:69], v27 offset:4096
    ds_read_b64_tr_b16 v[70:71], v27 offset:5120
    s_waitcnt lgkmcnt(9)
    v_mfma_f32_32x32x16_bf16 v[128:143], v[52:55], v[72:75], 0
    s_waitcnt lgkmcnt(6)
    v_mfma_f32_32x32x16_bf16 v[80:95], v[56:59], v[76:79], v[80:95]
    ds_read_b128 v[72:75], v30
    ds_read_b64_tr_b16 v[40:41], v24 offset:8192
    ds_read_b64_tr_b16 v[42:43], v24 offset:9216
    ds_read_b64_tr_b16 v[44:45], v25 offset:8192
    s_waitcnt lgkmcnt(8)
    v_mfma_f32_32x32x16_bf16 v[96:111], v[60:63], v[76:79], v[96:111]
    ds_read_b64_tr_b16 v[46:47], v25 offset:9216
    ds_read_b64_tr_b16 v[48:49], v26 offset:8192
    ds_read_b64_tr_b16 v[50:51], v26 offset:9216
    s_waitcnt lgkmcnt(9)
    v_mfma_f32_32x32x16_bf16 v[112:127], v[64:67], v[76:79], v[112:127]
    ds_read_b64_tr_b16 v[52:53], v27 offset:8192
    ds_read_b64_tr_b16 v[54:55], v27 offset:9216
    s_waitcnt lgkmcnt(9)
    v_mfma_f32_32x32x16_bf16 v[128:143], v[68:71], v[76:79], v[128:143]
    s_waitcnt lgkmcnt(6)
    v_mfma_f32_32x32x16_bf16 v[80:95], v[40:43], v[72:75], v[80:95]
    ds_read_b128 v[76:79], v31
    ds_read_b64_tr_b16 v[56:57], v24 offset:12288
    ds_read_b64_tr_b16 v[58:59], v24 offset:13312
    ds_read_b64_tr_b16 v[60:61], v25 offset:12288
    s_waitcnt lgkmcnt(8)
    v_mfma_f32_32x32x16_bf16 v[96:111], v[44:47], v[72:75], v[96:111]
    ds_read_b64_tr_b16 v[62:63], v25 offset:13312
    ds_read_b64_tr_b16 v[64:65], v26 offset:12288
    ds_read_b64_tr_b16 v[66:67], v26 offset:13312
    s_waitcnt lgkmcnt(9)
    v_mfma_f32_32x32x16_bf16 v[112:127], v[48:51], v[72:75], v[112:127]
    ds_read_b64_tr_b16 v[68:69], v27 offset:12288
    ds_read_b64_tr_b16 v[70:71], v27 offset:13312
    s_waitcnt lgkmcnt(9)
    v_mfma_f32_32x32x16_bf16 v[128:143], v[52:55], v[72:75], v[128:143]
    s_waitcnt vmcnt(8) lgkmcnt(0)
    s_barrier
    v_mfma_f32_32x32x16_bf16 v[80:95], v[56:59], v[76:79], v[80:95]
    v_add_u32 v28, 0x8000, v28
    ds_read_b128 v[72:75], v28
    v_add_u32 v24, 0x8000, v24
    ds_read_b64_tr_b16 v[40:41], v24 offset:0
    ds_read_b64_tr_b16 v[42:43], v24 offset:1024
    s_add_u32 m0, s81, 0
    s_nop 0
    buffer_load_dwordx4 v4, s[36:39], s75 offen lds
    v_mfma_f32_32x32x16_bf16 v[96:111], v[60:63], v[76:79], v[96:111]
    v_add_u32 v25, 0x8000, v25
    ds_read_b64_tr_b16 v[44:45], v25 offset:0
    ds_read_b64_tr_b16 v[46:47], v25 offset:1024
    v_mfma_f32_32x32x16_bf16 v[112:127], v[64:67], v[76:79], v[112:127]
    v_add_u32 v26, 0x8000, v26
    ds_read_b64_tr_b16 v[48:49], v26 offset:0
    ds_read_b64_tr_b16 v[50:51], v26 offset:1024
    buffer_load_dwordx4 v5, s[36:39], s75 offen offset:1024 lds
    v_mfma_f32_32x32x16_bf16 v[128:143], v[68:71], v[76:79], v[128:143]
    v_add_u32 v27, 0x8000, v27
    ds_read_b64_tr_b16 v[52:53], v27 offset:0
    ds_read_b64_tr_b16 v[54:55], v27 offset:1024
    v_add_u32 v29, 0x8000, v29
    v_add_u32 v30, 0x8000, v30
    v_add_u32 v31, 0x8000, v31
    s_waitcnt lgkmcnt(6)
    v_mfma_f32_32x32x16_bf16 v[80:95], v[40:43], v[72:75], v[80:95]
    ds_read_b128 v[76:79], v29
    ds_read_b64_tr_b16 v[56:57], v24 offset:4096
    ds_read_b64_tr_b16 v[58:59], v24 offset:5120
    ds_read_b64_tr_b16 v[60:61], v25 offset:4096
    buffer_load_dwordx4 v6, s[36:39], s75 offen offset:2048 lds
    s_waitcnt lgkmcnt(8)
    v_mfma_f32_32x32x16_bf16 v[96:111], v[44:47], v[72:75], v[96:111]
    ds_read_b64_tr_b16 v[62:63], v25 offset:5120
    ds_read_b64_tr_b16 v[64:65], v26 offset:4096
    ds_read_b64_tr_b16 v[66:67], v26 offset:5120
    s_waitcnt lgkmcnt(9)
    v_mfma_f32_32x32x16_bf16 v[112:127], v[48:51], v[72:75], v[112:127]
    ds_read_b64_tr_b16 v[68:69], v27 offset:4096
    ds_read_b64_tr_b16 v[70:71], v27 offset:5120
    buffer_load_dwordx4 v7, s[36:39], s75 offen offset:3072 lds
    s_add_u32 s75, s75, 524288
    s_bitset0_b32 s75, 22
    s_waitcnt lgkmcnt(9)
    v_mfma_f32_32x32x16_bf16 v[128:143], v[52:55], v[72:75], v[128:143]
    s_waitcnt lgkmcnt(6)
    v_mfma_f32_32x32x16_bf16 v[80:95], v[56:59], v[76:79], v[80:95]
    ds_read_b128 v[72:75], v30
    ds_read_b64_tr_b16 v[40:41], v24 offset:8192
    ds_read_b64_tr_b16 v[42:43], v24 offset:9216
    ds_read_b64_tr_b16 v[44:45], v25 offset:8192
    s_add_u32 m0, s82, 0
    s_nop 0
    buffer_load_dwordx4 v8, s[32:35], s76 offen lds
    s_waitcnt lgkmcnt(8)
    v_mfma_f32_32x32x16_bf16 v[96:111], v[60:63], v[76:79], v[96:111]
    ds_read_b64_tr_b16 v[46:47], v25 offset:9216
    ds_read_b64_tr_b16 v[48:49], v26 offset:8192
    ds_read_b64_tr_b16 v[50:51], v26 offset:9216
    s_waitcnt lgkmcnt(9)
    v_mfma_f32_32x32x16_bf16 v[112:127], v[64:67], v[76:79], v[112:127]
    ds_read_b64_tr_b16 v[52:53], v27 offset:8192
    ds_read_b64_tr_b16 v[54:55], v27 offset:9216
    buffer_load_dwordx4 v9, s[32:35], s76 offen offset:1024 lds
    s_waitcnt lgkmcnt(9)
    v_mfma_f32_32x32x16_bf16 v[128:143], v[68:71], v[76:79], v[128:143]
    s_waitcnt lgkmcnt(6)
    v_mfma_f32_32x32x16_bf16 v[80:95], v[40:43], v[72:75], v[80:95]
    ds_read_b128 v[76:79], v31
    ds_read_b64_tr_b16 v[56:57], v24 offset:12288
    ds_read_b64_tr_b16 v[58:59], v24 offset:13312
    ds_read_b64_tr_b16 v[60:61], v25 offset:12288
    buffer_load_dwordx4 v10, s[32:35], s76 offen offset:2048 lds
    s_waitcnt lgkmcnt(8)
    v_mfma_f32_32x32x16_bf16 v[96:111], v[44:47], v[72:75], v[96:111]
    ds_read_b64_tr_b16 v[62:63], v25 offset:13312
    ds_read_b64_tr_b16 v[64:65], v26 offset:12288
    ds_read_b64_tr_b16 v[66:67], v26 offset:13312
    s_waitcnt lgkmcnt(9)
    v_mfma_f32_32x32x16_bf16 v[112:127], v[48:51], v[72:75], v[112:127]
    ds_read_b64_tr_b16 v[68:69], v27 offset:12288
    ds_read_b64_tr_b16 v[70:71], v27 offset:13312
    buffer_load_dwordx4 v11, s[32:35], s76 offen offset:3072 lds
    s_add_u32 s76, s76, 128
    s_bitset0_b32 s76, 10
    s_waitcnt lgkmcnt(9)
    v_mfma_f32_32x32x16_bf16 v[128:143], v[52:55], v[72:75], v[128:143]
    s_waitcnt vmcnt(8) lgkmcnt(0)
    s_barrier
    v_mfma_f32_32x32x16_bf16 v[80:95], v[56:59], v[76:79], v[80:95]
    v_add_u32 v28, 0x8000, v28
    ds_read_b128 v[72:75], v28
    v_add_u32 v24, 0x8000, v24
    ds_read_b64_tr_b16 v[40:41], v24 offset:0
    ds_read_b64_tr_b16 v[42:43], v24 offset:1024
    s_add_u32 m0, s81, 32768
    s_nop 0
    buffer_load_dwordx4 v4, s[36:39], s75 offen lds
    v_mfma_f32_32x32x16_bf16 v[96:111], v[60:63], v[76:79], v[96:111]
    v_add_u32 v25, 0x8000, v25
    ds_read_b64_tr_b16 v[44:45], v25 offset:0
    ds_read_b64_tr_b16 v[46:47], v25 offset:1024
    v_mfma_f32_32x32x16_bf16 v[112:127], v[64:67], v[76:79], v[112:127]
    v_add_u32 v26, 0x8000, v26
    ds_read_b64_tr_b16 v[48:49], v26 offset:0
    ds_read_b64_tr_b16 v[50:51], v26 offset:1024
    buffer_load_dwordx4 v5, s[36:39], s75 offen offset:1024 lds
    v_mfma_f32_32x32x16_bf16 v[128:143], v[68:71], v[76:79], v[128:143]
    v_add_u32 v27, 0x8000, v27
    ds_read_b64_tr_b16 v[52:53], v27 offset:0
    ds_read_b64_tr_b16 v[54:55], v27 offset:1024
    v_add_u32 v29, 0x8000, v29
    v_add_u32 v30, 0x8000, v30
    v_add_u32 v31, 0x8000, v31
    s_waitcnt lgkmcnt(6)
    v_mfma_f32_32x32x16_bf16 v[80:95], v[40:43], v[72:75], v[80:95]
    ds_read_b128 v[76:79], v29
    ds_read_b64_tr_b16 v[56:57], v24 offset:4096
    ds_read_b64_tr_b16 v[58:59], v24 offset:5120
    ds_read_b64_tr_b16 v[60:61], v25 offset:4096
    buffer_load_dwordx4 v6, s[36:39], s75 offen offset:2048 lds
    s_waitcnt lgkmcnt(8)
    v_mfma_f32_32x32x16_bf16 v[96:111], v[44:47], v[72:75], v[96:111]
    ds_read_b64_tr_b16 v[62:63], v25 offset:5120
    ds_read_b64_tr_b16 v[64:65], v26 offset:4096
    ds_read_b64_tr_b16 v[66:67], v26 offset:5120
    s_waitcnt lgkmcnt(9)
    v_mfma_f32_32x32x16_bf16 v[112:127], v[48:51], v[72:75], v[112:127]
    ds_read_b64_tr_b16 v[68:69], v27 offset:4096
    ds_read_b64_tr_b16 v[70:71], v27 offset:5120
    buffer_load_dwordx4 v7, s[36:39], s75 offen offset:3072 lds
    s_add_u32 s75, s75, 524288
    s_bitset0_b32 s75, 22
    s_waitcnt lgkmcnt(9)
    v_mfma_f32_32x32x16_bf16 v[128:143], v[52:55], v[72:75], v[128:143]
    s_waitcnt lgkmcnt(6)
    v_mfma_f32_32x32x16_bf16 v[80:95], v[56:59], v[76:79], v[80:95]
    ds_read_b128 v[72:75], v30
    ds_read_b64_tr_b16 v[40:41], v24 offset:8192
    ds_read_b64_tr_b16 v[42:43], v24 offset:9216
    ds_read_b64_tr_b16 v[44:45], v25 offset:8192
    s_add_u32 m0, s82, 32768
    s_nop 0
    buffer_load_dwordx4 v8, s[32:35], s76 offen lds
    s_waitcnt lgkmcnt(8)
    v_mfma_f32_32x32x16_bf16 v[96:111], v[60:63], v[76:79], v[96:111]
    ds_read_b64_tr_b16 v[46:47], v25 offset:9216
    ds_read_b64_tr_b16 v[48:49], v26 offset:8192
    ds_read_b64_tr_b16 v[50:51], v26 offset:9216
    s_waitcnt lgkmcnt(9)
    v_mfma_f32_32x32x16_bf16 v[112:127], v[64:67], v[76:79], v[112:127]
    ds_read_b64_tr_b16 v[52:53], v27 offset:8192
    ds_read_b64_tr_b16 v[54:55], v27 offset:9216
    buffer_load_dwordx4 v9, s[32:35], s76 offen offset:1024 lds
    s_waitcnt lgkmcnt(9)
    v_mfma_f32_32x32x16_bf16 v[128:143], v[68:71], v[76:79], v[128:143]
    s_waitcnt lgkmcnt(6)
    v_mfma_f32_32x32x16_bf16 v[80:95], v[40:43], v[72:75], v[80:95]
    ds_read_b128 v[76:79], v31
    ds_read_b64_tr_b16 v[56:57], v24 offset:12288
    ds_read_b64_tr_b16 v[58:59], v24 offset:13312
    ds_read_b64_tr_b16 v[60:61], v25 offset:12288
    buffer_load_dwordx4 v10, s[32:35], s76 offen offset:2048 lds
    s_waitcnt lgkmcnt(8)
    v_mfma_f32_32x32x16_bf16 v[96:111], v[44:47], v[72:75], v[96:111]
    ds_read_b64_tr_b16 v[62:63], v25 offset:13312
    ds_read_b64_tr_b16 v[64:65], v26 offset:12288
    ds_read_b64_tr_b16 v[66:67], v26 offset:13312
    s_waitcnt lgkmcnt(9)
    v_mfma_f32_32x32x16_bf16 v[112:127], v[48:51], v[72:75], v[112:127]
    ds_read_b64_tr_b16 v[68:69], v27 offset:12288
    ds_read_b64_tr_b16 v[70:71], v27 offset:13312
    buffer_load_dwordx4 v11, s[32:35], s76 offen offset:3072 lds
    s_add_u32 s76, s76, 128
    s_bitset0_b32 s76, 10
    s_waitcnt lgkmcnt(9)
    v_mfma_f32_32x32x16_bf16 v[128:143], v[52:55], v[72:75], v[128:143]
    s_waitcnt vmcnt(8) lgkmcnt(0)
    s_barrier
    v_mfma_f32_32x32x16_bf16 v[80:95], v[56:59], v[76:79], v[80:95]
    v_add_u32 v28, 0xffff0000, v28
    ds_read_b128 v[72:75], v28
    v_add_u32 v24, 0xffff0000, v24
    ds_read_b64_tr_b16 v[40:41], v24 offset:0
    ds_read_b64_tr_b16 v[42:43], v24 offset:1024
    s_add_u32 m0, s81, 65536
    s_nop 0
    buffer_load_dwordx4 v4, s[36:39], s75 offen lds
    v_mfma_f32_32x32x16_bf16 v[96:111], v[60:63], v[76:79], v[96:111]
    v_add_u32 v25, 0xffff0000, v25
    ds_read_b64_tr_b16 v[44:45], v25 offset:0
    ds_read_b64_tr_b16 v[46:47], v25 offset:1024
    v_mfma_f32_32x32x16_bf16 v[112:127], v[64:67], v[76:79], v[112:127]
    v_add_u32 v26, 0xffff0000, v26
    ds_read_b64_tr_b16 v[48:49], v26 offset:0
    ds_read_b64_tr_b16 v[50:51], v26 offset:1024
    buffer_load_dwordx4 v5, s[36:39], s75 offen offset:1024 lds
    v_mfma_f32_32x32x16_bf16 v[128:143], v[68:71], v[76:79], v[128:143]
    v_add_u32 v27, 0xffff0000, v27
    ds_read_b64_tr_b16 v[52:53], v27 offset:0
    ds_read_b64_tr_b16 v[54:55], v27 offset:1024
    v_add_u32 v29, 0xffff0000, v29
    v_add_u32 v30, 0xffff0000, v30
    v_add_u32 v31, 0xffff0000, v31
    s_waitcnt lgkmcnt(6)
    v_mfma_f32_32x32x16_bf16 v[80:95], v[40:43], v[72:75], v[80:95]
    ds_read_b128 v[76:79], v29
    ds_read_b64_tr_b16 v[56:57], v24 offset:4096
    ds_read_b64_tr_b16 v[58:59], v24 offset:5120
    ds_read_b64_tr_b16 v[60:61], v25 offset:4096
    buffer_load_dwordx4 v6, s[36:39], s75 offen offset:2048 lds
    s_waitcnt lgkmcnt(8)
    v_mfma_f32_32x32x16_bf16 v[96:111], v[44:47], v[72:75], v[96:111]
    ds_read_b64_tr_b16 v[62:63], v25 offset:5120
    ds_read_b64_tr_b16 v[64:65], v26 offset:4096
    ds_read_b64_tr_b16 v[66:67], v26 offset:5120
    s_waitcnt lgkmcnt(9)
    v_mfma_f32_32x32x16_bf16 v[112:127], v[48:51], v[72:75], v[112:127]
    ds_read_b64_tr_b16 v[68:69], v27 offset:4096
    ds_read_b64_tr_b16 v[70:71], v27 offset:5120
    buffer_load_dwordx4 v7, s[36:39], s75 offen offset:3072 lds
    s_add_u32 s75, s75, 524288
    s_bitset0_b32 s75, 22
    s_waitcnt lgkmcnt(9)
    v_mfma_f32_32x32x16_bf16 v[128:143], v[52:55], v[72:75], v[128:143]
    s_waitcnt lgkmcnt(6)
    v_mfma_f32_32x32x16_bf16 v[80:95], v[56:59], v[76:79], v[80:95]
    ds_read_b128 v[72:75], v30
    ds_read_b64_tr_b16 v[40:41], v24 offset:8192
    ds_read_b64_tr_b16 v[42:43], v24 offset:9216
    ds_read_b64_tr_b16 v[44:45], v25 offset:8192
    s_add_u32 m0, s82, 65536
    s_nop 0
    buffer_load_dwordx4 v8, s[32:35], s76 offen lds
    s_waitcnt lgkmcnt(8)
    v_mfma_f32_32x32x16_bf16 v[96:111], v[60:63], v[76:79], v[96:111]
    ds_read_b64_tr_b16 v[46:47], v25 offset:9216
    ds_read_b64_tr_b16 v[48:49], v26 offset:8192
    ds_read_b64_tr_b16 v[50:51], v26 offset:9216
    s_waitcnt lgkmcnt(9)
    v_mfma_f32_32x32x16_bf16 v[112:127], v[64:67], v[76:79], v[112:127]
    ds_read_b64_tr_b16 v[52:53], v27 offset:8192
    ds_read_b64_tr_b16 v[54:55], v27 offset:9216
    buffer_load_dwordx4 v9, s[32:35], s76 offen offset:1024 lds
    s_waitcnt lgkmcnt(9)
    v_mfma_f32_32x32x16_bf16 v[128:143], v[68:71], v[76:79], v[128:143]
    s_waitcnt lgkmcnt(6)
    v_mfma_f32_32x32x16_bf16 v[80:95], v[40:43], v[72:75], v[80:95]
    ds_read_b128 v[76:79], v31
    ds_read_b64_tr_b16 v[56:57], v24 offset:12288
    ds_read_b64_tr_b16 v[58:59], v24 offset:13312
    ds_read_b64_tr_b16 v[60:61], v25 offset:12288
    buffer_load_dwordx4 v10, s[32:35], s76 offen offset:2048 lds
    s_waitcnt lgkmcnt(8)
    v_mfma_f32_32x32x16_bf16 v[96:111], v[44:47], v[72:75], v[96:111]
    ds_read_b64_tr_b16 v[62:63], v25 offset:13312
    ds_read_b64_tr_b16 v[64:65], v26 offset:12288
    ds_read_b64_tr_b16 v[66:67], v26 offset:13312
    s_waitcnt lgkmcnt(9)
    v_mfma_f32_32x32x16_bf16 v[112:127], v[48:51], v[72:75], v[112:127]
    ds_read_b64_tr_b16 v[68:69], v27 offset:12288
    ds_read_b64_tr_b16 v[70:71], v27 offset:13312
    buffer_load_dwordx4 v11, s[32:35], s76 offen offset:3072 lds
    s_add_u32 s76, s76, 128
    s_bitset0_b32 s76, 10
    s_waitcnt lgkmcnt(9)
    v_mfma_f32_32x32x16_bf16 v[128:143], v[52:55], v[72:75], v[128:143]
    s_waitcnt vmcnt(8) lgkmcnt(0)
    s_barrier
    v_mfma_f32_32x32x16_bf16 v[80:95], v[56:59], v[76:79], v[80:95]
    v_add_u32 v28, 0x8000, v28
    ds_read_b128 v[72:75], v28
    v_add_u32 v24, 0x8000, v24
    ds_read_b64_tr_b16 v[40:41], v24 offset:0
    ds_read_b64_tr_b16 v[42:43], v24 offset:1024
    s_add_u32 m0, s81, 0
    s_nop 0
    buffer_load_dwordx4 v4, s[36:39], s75 offen lds
    v_mfma_f32_32x32x16_bf16 v[96:111], v[60:63], v[76:79], v[96:111]
    v_add_u32 v25, 0x8000, v25
    ds_read_b64_tr_b16 v[44:45], v25 offset:0
    ds_read_b64_tr_b16 v[46:47], v25 offset:1024
    v_mfma_f32_32x32x16_bf16 v[112:127], v[64:67], v[76:79], v[112:127]
    v_add_u32 v26, 0x8000, v26
    ds_read_b64_tr_b16 v[48:49], v26 offset:0
    ds_read_b64_tr_b16 v[50:51], v26 offset:1024
    buffer_load_dwordx4 v5, s[36:39], s75 offen offset:1024 lds
    v_mfma_f32_32x32x16_bf16 v[128:143], v[68:71], v[76:79], v[128:143]
    v_add_u32 v27, 0x8000, v27
    ds_read_b64_tr_b16 v[52:53], v27 offset:0
    ds_read_b64_tr_b16 v[54:55], v27 offset:1024
    v_add_u32 v29, 0x8000, v29
    v_add_u32 v30, 0x8000, v30
    v_add_u32 v31, 0x8000, v31
    s_waitcnt lgkmcnt(6)
    v_mfma_f32_32x32x16_bf16 v[80:95], v[40:43], v[72:75], v[80:95]
    ds_read_b128 v[76:79], v29
    ds_read_b64_tr_b16 v[56:57], v24 offset:4096
    ds_read_b64_tr_b16 v[58:59], v24 offset:5120
    ds_read_b64_tr_b16 v[60:61], v25 offset:4096
    buffer_load_dwordx4 v6, s[36:39], s75 offen offset:2048 lds
    s_waitcnt lgkmcnt(8)
    v_mfma_f32_32x32x16_bf16 v[96:111], v[44:47], v[72:75], v[96:111]
    ds_read_b64_tr_b16 v[62:63], v25 offset:5120
    ds_read_b64_tr_b16 v[64:65], v26 offset:4096
    ds_read_b64_tr_b16 v[66:67], v26 offset:5120
    s_waitcnt lgkmcnt(9)
    v_mfma_f32_32x32x16_bf16 v[112:127], v[48:51], v[72:75], v[112:127]
    ds_read_b64_tr_b16 v[68:69], v27 offset:4096
    ds_read_b64_tr_b16 v[70:71], v27 offset:5120
    buffer_load_dwordx4 v7, s[36:39], s75 offen offset:3072 lds
    s_add_u32 s75, s75, 524288
    s_bitset0_b32 s75, 22
    s_waitcnt lgkmcnt(9)
    v_mfma_f32_32x32x16_bf16 v[128:143], v[52:55], v[72:75], v[128:143]
    s_waitcnt lgkmcnt(6)
    v_mfma_f32_32x32x16_bf16 v[80:95], v[56:59], v[76:79], v[80:95]
    ds_read_b128 v[72:75], v30
    ds_read_b64_tr_b16 v[40:41], v24 offset:8192
    ds_read_b64_tr_b16 v[42:43], v24 offset:9216
    ds_read_b64_tr_b16 v[44:45], v25 offset:8192
    s_add_u32 m0, s82, 0
    s_nop 0
    buffer_load_dwordx4 v8, s[32:35], s76 offen lds
    s_waitcnt lgkmcnt(8)
    v_mfma_f32_32x32x16_bf16 v[96:111], v[60:63], v[76:79], v[96:111]
    ds_read_b64_tr_b16 v[46:47], v25 offset:9216
    ds_read_b64_tr_b16 v[48:49], v26 offset:8192
    ds_read_b64_tr_b16 v[50:51], v26 offset:9216
    s_waitcnt lgkmcnt(9)
    v_mfma_f32_32x32x16_bf16 v[112:127], v[64:67], v[76:79], v[112:127]
    ds_read_b64_tr_b16 v[52:53], v27 offset:8192
    ds_read_b64_tr_b16 v[54:55], v27 offset:9216
    buffer_load_dwordx4 v9, s[32:35], s76 offen offset:1024 lds
    s_waitcnt lgkmcnt(9)
    v_mfma_f32_32x32x16_bf16 v[128:143], v[68:71], v[76:79], v[128:143]
    s_waitcnt lgkmcnt(6)
    v_mfma_f32_32x32x16_bf16 v[80:95], v[40:43], v[72:75], v[80:95]
    ds_read_b128 v[76:79], v31
    ds_read_b64_tr_b16 v[56:57], v24 offset:12288
    ds_read_b64_tr_b16 v[58:59], v24 offset:13312
    ds_read_b64_tr_b16 v[60:61], v25 offset:12288
    buffer_load_dwordx4 v10, s[32:35], s76 offen offset:2048 lds
    s_waitcnt lgkmcnt(8)
    v_mfma_f32_32x32x16_bf16 v[96:111], v[44:47], v[72:75], v[96:111]
    ds_read_b64_tr_b16 v[62:63], v25 offset:13312
    ds_read_b64_tr_b16 v[64:65], v26 offset:12288
    ds_read_b64_tr_b16 v[66:67], v26 offset:13312
    s_waitcnt lgkmcnt(9)
    v_mfma_f32_32x32x16_bf16 v[112:127], v[48:51], v[72:75], v[112:127]
    ds_read_b64_tr_b16 v[68:69], v27 offset:12288
    ds_read_b64_tr_b16 v[70:71], v27 offset:13312
    buffer_load_dwordx4 v11, s[32:35], s76 offen offset:3072 lds
    s_add_u32 s76, s76, 128
    s_bitset0_b32 s76, 10
    s_waitcnt lgkmcnt(9)
    v_mfma_f32_32x32x16_bf16 v[128:143], v[52:55], v[72:75], v[128:143]
    s_waitcnt vmcnt(8) lgkmcnt(0)
    s_barrier
    v_mfma_f32_32x32x16_bf16 v[80:95], v[56:59], v[76:79], v[80:95]
    v_add_u32 v28, 0x8000, v28
    ds_read_b128 v[72:75], v28
    v_add_u32 v24, 0x8000, v24
    ds_read_b64_tr_b16 v[40:41], v24 offset:0
    ds_read_b64_tr_b16 v[42:43], v24 offset:1024
    s_add_u32 m0, s81, 32768
    s_nop 0
    buffer_load_dwordx4 v4, s[36:39], s75 offen lds
    v_mfma_f32_32x32x16_bf16 v[96:111], v[60:63], v[76:79], v[96:111]
    v_add_u32 v25, 0x8000, v25
    ds_read_b64_tr_b16 v[44:45], v25 offset:0
    ds_read_b64_tr_b16 v[46:47], v25 offset:1024
    v_mfma_f32_32x32x16_bf16 v[112:127], v[64:67], v[76:79], v[112:127]
    v_add_u32 v26, 0x8000, v26
    ds_read_b64_tr_b16 v[48:49], v26 offset:0
    ds_read_b64_tr_b16 v[50:51], v26 offset:1024
    buffer_load_dwordx4 v5, s[36:39], s75 offen offset:1024 lds
    v_mfma_f32_32x32x16_bf16 v[128:143], v[68:71], v[76:79], v[128:143]
    v_add_u32 v27, 0x8000, v27
    ds_read_b64_tr_b16 v[52:53], v27 offset:0
    ds_read_b64_tr_b16 v[54:55], v27 offset:1024
    v_add_u32 v29, 0x8000, v29
    v_add_u32 v30, 0x8000, v30
    v_add_u32 v31, 0x8000, v31
    s_waitcnt lgkmcnt(6)
    v_mfma_f32_32x32x16_bf16 v[80:95], v[40:43], v[72:75], v[80:95]
    ds_read_b128 v[76:79], v29
    ds_read_b64_tr_b16 v[56:57], v24 offset:4096
    ds_read_b64_tr_b16 v[58:59], v24 offset:5120
    ds_read_b64_tr_b16 v[60:61], v25 offset:4096
    buffer_load_dwordx4 v6, s[36:39], s75 offen offset:2048 lds
    s_waitcnt lgkmcnt(8)
    v_mfma_f32_32x32x16_bf16 v[96:111], v[44:47], v[72:75], v[96:111]
    ds_read_b64_tr_b16 v[62:63], v25 offset:5120
    ds_read_b64_tr_b16 v[64:65], v26 offset:4096
    ds_read_b64_tr_b16 v[66:67], v26 offset:5120
    s_waitcnt lgkmcnt(9)
    v_mfma_f32_32x32x16_bf16 v[112:127], v[48:51], v[72:75], v[112:127]
    ds_read_b64_tr_b16 v[68:69], v27 offset:4096
    ds_read_b64_tr_b16 v[70:71], v27 offset:5120
    buffer_load_dwordx4 v7, s[36:39], s75 offen offset:3072 lds
    s_add_u32 s75, s75, 524288
    s_bitset0_b32 s75, 22
    s_waitcnt lgkmcnt(9)
    v_mfma_f32_32x32x16_bf16 v[128:143], v[52:55], v[72:75], v[128:143]
    s_waitcnt lgkmcnt(6)
    v_mfma_f32_32x32x16_bf16 v[80:95], v[56:59], v[76:79], v[80:95]
    ds_read_b128 v[72:75], v30
    ds_read_b64_tr_b16 v[40:41], v24 offset:8192
    ds_read_b64_tr_b16 v[42:43], v24 offset:9216
    ds_read_b64_tr_b16 v[44:45], v25 offset:8192
    s_add_u32 m0, s82, 32768
    s_nop 0
    buffer_load_dwordx4 v8, s[32:35], s76 offen lds
    s_waitcnt lgkmcnt(8)
    v_mfma_f32_32x32x16_bf16 v[96:111], v[60:63], v[76:79], v[96:111]
    ds_read_b64_tr_b16 v[46:47], v25 offset:9216
    ds_read_b64_tr_b16 v[48:49], v26 offset:8192
    ds_read_b64_tr_b16 v[50:51], v26 offset:9216
    s_waitcnt lgkmcnt(9)
    v_mfma_f32_32x32x16_bf16 v[112:127], v[64:67], v[76:79], v[112:127]
    ds_read_b64_tr_b16 v[52:53], v27 offset:8192
    ds_read_b64_tr_b16 v[54:55], v27 offset:9216
    buffer_load_dwordx4 v9, s[32:35], s76 offen offset:1024 lds
    s_waitcnt lgkmcnt(9)
    v_mfma_f32_32x32x16_bf16 v[128:143], v[68:71], v[76:79], v[128:143]
    s_waitcnt lgkmcnt(6)
    v_mfma_f32_32x32x16_bf16 v[80:95], v[40:43], v[72:75], v[80:95]
    ds_read_b128 v[76:79], v31
    ds_read_b64_tr_b16 v[56:57], v24 offset:12288
    ds_read_b64_tr_b16 v[58:59], v24 offset:13312
    ds_read_b64_tr_b16 v[60:61], v25 offset:12288
    buffer_load_dwordx4 v10, s[32:35], s76 offen offset:2048 lds
    s_waitcnt lgkmcnt(8)
    v_mfma_f32_32x32x16_bf16 v[96:111], v[44:47], v[72:75], v[96:111]
    ds_read_b64_tr_b16 v[62:63], v25 offset:13312
    ds_read_b64_tr_b16 v[64:65], v26 offset:12288
    ds_read_b64_tr_b16 v[66:67], v26 offset:13312
    s_waitcnt lgkmcnt(9)
    v_mfma_f32_32x32x16_bf16 v[112:127], v[48:51], v[72:75], v[112:127]
    ds_read_b64_tr_b16 v[68:69], v27 offset:12288
    ds_read_b64_tr_b16 v[70:71], v27 offset:13312
    buffer_load_dwordx4 v11, s[32:35], s76 offen offset:3072 lds
    s_add_u32 s76, s76, 128
    s_bitset0_b32 s76, 10
    s_waitcnt lgkmcnt(9)
    v_mfma_f32_32x32x16_bf16 v[128:143], v[52:55], v[72:75], v[128:143]
    s_waitcnt vmcnt(8) lgkmcnt(0)
    s_barrier
    v_mfma_f32_32x32x16_bf16 v[80:95], v[56:59], v[76:79], v[80:95]
    v_add_u32 v28, 0xffff0000, v28
    ds_read_b128 v[72:75], v28
    v_add_u32 v24, 0xffff0000, v24
    ds_read_b64_tr_b16 v[40:41], v24 offset:0
    ds_read_b64_tr_b16 v[42:43], v24 offset:1024
    v_mfma_f32_32x32x16_bf16 v[96:111], v[60:63], v[76:79], v[96:111]
    v_add_u32 v25, 0xffff0000, v25
    ds_read_b64_tr_b16 v[44:45], v25 offset:0
    ds_read_b64_tr_b16 v[46:47], v25 offset:1024
    v_mfma_f32_32x32x16_bf16 v[112:127], v[64:67], v[76:79], v[112:127]
    v_add_u32 v26, 0xffff0000, v26
    ds_read_b64_tr_b16 v[48:49], v26 offset:0
    ds_read_b64_tr_b16 v[50:51], v26 offset:1024
    v_mfma_f32_32x32x16_bf16 v[128:143], v[68:71], v[76:79], v[128:143]
    v_add_u32 v27, 0xffff0000, v27
    ds_read_b64_tr_b16 v[52:53], v27 offset:0
    ds_read_b64_tr_b16 v[54:55], v27 offset:1024
    v_add_u32 v29, 0xffff0000, v29
    v_add_u32 v30, 0xffff0000, v30
    v_add_u32 v31, 0xffff0000, v31
    s_waitcnt lgkmcnt(6)
    v_mfma_f32_32x32x16_bf16 v[80:95], v[40:43], v[72:75], v[80:95]
    ds_read_b128 v[76:79], v29
    ds_read_b64_tr_b16 v[56:57], v24 offset:4096
    ds_read_b64_tr_b16 v[58:59], v24 offset:5120
    ds_read_b64_tr_b16 v[60:61], v25 offset:4096
    s_waitcnt lgkmcnt(8)
    v_mfma_f32_32x32x16_bf16 v[96:111], v[44:47], v[72:75], v[96:111]
    ds_read_b64_tr_b16 v[62:63], v25 offset:5120
    ds_read_b64_tr_b16 v[64:65], v26 offset:4096
    ds_read_b64_tr_b16 v[66:67], v26 offset:5120
    s_waitcnt lgkmcnt(9)
    v_mfma_f32_32x32x16_bf16 v[112:127], v[48:51], v[72:75], v[112:127]
    ds_read_b64_tr_b16 v[68:69], v27 offset:4096
    ds_read_b64_tr_b16 v[70:71], v27 offset:5120
    s_waitcnt lgkmcnt(9)
    v_mfma_f32_32x32x16_bf16 v[128:143], v[52:55], v[72:75], v[128:143]
    s_waitcnt lgkmcnt(6)
    v_mfma_f32_32x32x16_bf16 v[80:95], v[56:59], v[76:79], v[80:95]
    ds_read_b128 v[72:75], v30
    ds_read_b64_tr_b16 v[40:41], v24 offset:8192
    ds_read_b64_tr_b16 v[42:43], v24 offset:9216
    ds_read_b64_tr_b16 v[44:45], v25 offset:8192
    s_waitcnt lgkmcnt(8)
    v_mfma_f32_32x32x16_bf16 v[96:111], v[60:63], v[76:79], v[96:111]
    ds_read_b64_tr_b16 v[46:47], v25 offset:9216
    ds_read_b64_tr_b16 v[48:49], v26 offset:8192
    ds_read_b64_tr_b16 v[50:51], v26 offset:9216
    s_waitcnt lgkmcnt(9)
    v_mfma_f32_32x32x16_bf16 v[112:127], v[64:67], v[76:79], v[112:127]
    ds_read_b64_tr_b16 v[52:53], v27 offset:8192
    ds_read_b64_tr_b16 v[54:55], v27 offset:9216
    s_waitcnt lgkmcnt(9)
    v_mfma_f32_32x32x16_bf16 v[128:143], v[68:71], v[76:79], v[128:143]
    s_waitcnt lgkmcnt(6)
    v_mfma_f32_32x32x16_bf16 v[80:95], v[40:43], v[72:75], v[80:95]
    ds_read_b128 v[76:79], v31
    ds_read_b64_tr_b16 v[56:57], v24 offset:12288
    ds_read_b64_tr_b16 v[58:59], v24 offset:13312
    ds_read_b64_tr_b16 v[60:61], v25 offset:12288
    s_waitcnt lgkmcnt(8)
    v_mfma_f32_32x32x16_bf16 v[96:111], v[44:47], v[72:75], v[96:111]
    ds_read_b64_tr_b16 v[62:63], v25 offset:13312
    ds_read_b64_tr_b16 v[64:65], v26 offset:12288
    ds_read_b64_tr_b16 v[66:67], v26 offset:13312
    s_waitcnt lgkmcnt(9)
    v_mfma_f32_32x32x16_bf16 v[112:127], v[48:51], v[72:75], v[112:127]
    ds_read_b64_tr_b16 v[68:69], v27 offset:12288
    ds_read_b64_tr_b16 v[70:71], v27 offset:13312
    s_waitcnt lgkmcnt(9)
    v_mfma_f32_32x32x16_bf16 v[128:143], v[52:55], v[72:75], v[128:143]
    s_waitcnt vmcnt(0) lgkmcnt(0)
    s_barrier
    buffer_load_dword v252, v254, s[60:63], 0 offen sc1
    buffer_load_dword v248, v246, s[52:55], s79 offen sc1
    v_mfma_f32_32x32x16_bf16 v[80:95], v[56:59], v[76:79], v[80:95]
    v_add_u32 v28, 0x8000, v28
    ds_read_b128 v[72:75], v28
    v_add_u32 v24, 0x8000, v24
    ds_read_b64_tr_b16 v[40:41], v24 offset:0
    ds_read_b64_tr_b16 v[42:43], v24 offset:1024
    v_mfma_f32_32x32x16_bf16 v[96:111], v[60:63], v[76:79], v[96:111]
    v_add_u32 v25, 0x8000, v25
    ds_read_b64_tr_b16 v[44:45], v25 offset:0
    ds_read_b64_tr_b16 v[46:47], v25 offset:1024
    v_mfma_f32_32x32x16_bf16 v[112:127], v[64:67], v[76:79], v[112:127]
    v_add_u32 v26, 0x8000, v26
    ds_read_b64_tr_b16 v[48:49], v26 offset:0
    ds_read_b64_tr_b16 v[50:51], v26 offset:1024
    v_mfma_f32_32x32x16_bf16 v[128:143], v[68:71], v[76:79], v[128:143]
    v_add_u32 v27, 0x8000, v27
    ds_read_b64_tr_b16 v[52:53], v27 offset:0
    ds_read_b64_tr_b16 v[54:55], v27 offset:1024
    v_add_u32 v29, 0x8000, v29
    v_add_u32 v30, 0x8000, v30
    v_add_u32 v31, 0x8000, v31
    s_waitcnt lgkmcnt(6)
    v_mfma_f32_32x32x16_bf16 v[80:95], v[40:43], v[72:75], v[80:95]
    ds_read_b128 v[76:79], v29
    ds_read_b64_tr_b16 v[56:57], v24 offset:4096
    ds_read_b64_tr_b16 v[58:59], v24 offset:5120
    ds_read_b64_tr_b16 v[60:61], v25 offset:4096
    s_waitcnt lgkmcnt(8)
    v_mfma_f32_32x32x16_bf16 v[96:111], v[44:47], v[72:75], v[96:111]
    ds_read_b64_tr_b16 v[62:63], v25 offset:5120
    ds_read_b64_tr_b16 v[64:65], v26 offset:4096
    ds_read_b64_tr_b16 v[66:67], v26 offset:5120
    s_waitcnt lgkmcnt(9)
    v_mfma_f32_32x32x16_bf16 v[112:127], v[48:51], v[72:75], v[112:127]
    ds_read_b64_tr_b16 v[68:69], v27 offset:4096
    ds_read_b64_tr_b16 v[70:71], v27 offset:5120
    s_waitcnt lgkmcnt(9)
    v_mfma_f32_32x32x16_bf16 v[128:143], v[52:55], v[72:75], v[128:143]
    s_waitcnt lgkmcnt(6)
    v_mfma_f32_32x32x16_bf16 v[80:95], v[56:59], v[76:79], v[80:95]
    ds_read_b128 v[72:75], v30
    ds_read_b64_tr_b16 v[40:41], v24 offset:8192
    ds_read_b64_tr_b16 v[42:43], v24 offset:9216
    ds_read_b64_tr_b16 v[44:45], v25 offset:8192
    s_waitcnt lgkmcnt(8)
    v_mfma_f32_32x32x16_bf16 v[96:111], v[60:63], v[76:79], v[96:111]
    ds_read_b64_tr_b16 v[46:47], v25 offset:9216
    ds_read_b64_tr_b16 v[48:49], v26 offset:8192
    ds_read_b64_tr_b16 v[50:51], v26 offset:9216
    s_waitcnt lgkmcnt(9)
    v_mfma_f32_32x32x16_bf16 v[112:127], v[64:67], v[76:79], v[112:127]
    ds_read_b64_tr_b16 v[52:53], v27 offset:8192
    ds_read_b64_tr_b16 v[54:55], v27 offset:9216
    s_waitcnt lgkmcnt(9)
    v_mfma_f32_32x32x16_bf16 v[128:143], v[68:71], v[76:79], v[128:143]
    s_waitcnt lgkmcnt(6)
    v_mfma_f32_32x32x16_bf16 v[80:95], v[40:43], v[72:75], v[80:95]
    ds_read_b128 v[76:79], v31
    ds_read_b64_tr_b16 v[56:57], v24 offset:12288
    ds_read_b64_tr_b16 v[58:59], v24 offset:13312
    ds_read_b64_tr_b16 v[60:61], v25 offset:12288
    s_waitcnt lgkmcnt(8)
    v_mfma_f32_32x32x16_bf16 v[96:111], v[44:47], v[72:75], v[96:111]
    ds_read_b64_tr_b16 v[62:63], v25 offset:13312
    ds_read_b64_tr_b16 v[64:65], v26 offset:12288
    ds_read_b64_tr_b16 v[66:67], v26 offset:13312
    s_waitcnt lgkmcnt(9)
    v_mfma_f32_32x32x16_bf16 v[112:127], v[48:51], v[72:75], v[112:127]
    ds_read_b64_tr_b16 v[68:69], v27 offset:12288
    ds_read_b64_tr_b16 v[70:71], v27 offset:13312
    s_waitcnt lgkmcnt(9)
    v_mfma_f32_32x32x16_bf16 v[128:143], v[52:55], v[72:75], v[128:143]
    s_waitcnt lgkmcnt(0)
    s_barrier
    v_mfma_f32_32x32x16_bf16 v[80:95], v[56:59], v[76:79], v[80:95]
    ds_read_b128 v[192:195], v18
    v_xor_b32 v33, 32, v18
    ds_read_b128 v[196:199], v33
    v_mfma_f32_32x32x16_bf16 v[96:111], v[60:63], v[76:79], v[96:111]
    v_xor_b32 v32, 64, v18
    ds_read_b128 v[200:203], v32
    v_xor_b32 v33, 96, v18
    ds_read_b128 v[204:207], v33
    v_mfma_f32_32x32x16_bf16 v[112:127], v[64:67], v[76:79], v[112:127]
    v_xor_b32 v32, 128, v18
    ds_read_b128 v[208:211], v32
    v_xor_b32 v33, 160, v18
    ds_read_b128 v[212:215], v33
    v_mfma_f32_32x32x16_bf16 v[128:143], v[68:71], v[76:79], v[128:143]
    v_xor_b32 v32, 192, v18
    ds_read_b128 v[216:219], v32
    v_xor_b32 v33, 224, v18
    ds_read_b128 v[220:223], v33
    s_mov_b32 s84, 0x3e0293ee
    v_xor_b32 v25, 64, v19
    v_xor_b32 v26, 128, v19
    v_xor_b32 v27, 192, v19
    v_cvt_pk_bf16_f32 v144, v80, v81
    v_cvt_pk_bf16_f32 v145, v82, v83
    v_cvt_pk_bf16_f32 v146, v84, v85
    v_cvt_pk_bf16_f32 v147, v86, v87
    v_cvt_pk_bf16_f32 v148, v88, v89
    v_cvt_pk_bf16_f32 v149, v90, v91
    v_cvt_pk_bf16_f32 v150, v92, v93
    v_cvt_pk_bf16_f32 v151, v94, v95
    s_waitcnt lgkmcnt(7)
    v_mfma_f32_32x32x16_bf16 v[176:191], v[192:195], v[144:147], 0
    v_cvt_pk_bf16_f32 v152, v96, v97
    v_cvt_pk_bf16_f32 v153, v98, v99
    v_cvt_pk_bf16_f32 v154, v100, v101
    v_cvt_pk_bf16_f32 v155, v102, v103
    s_waitcnt lgkmcnt(6)
    v_mfma_f32_32x32x16_bf16 v[176:191], v[196:199], v[148:151], v[176:191]
    v_cvt_pk_bf16_f32 v156, v104, v105
    v_cvt_pk_bf16_f32 v157, v106, v107
    v_cvt_pk_bf16_f32 v158, v108, v109
    v_cvt_pk_bf16_f32 v159, v110, v111
    s_waitcnt lgkmcnt(5)
    v_mfma_f32_32x32x16_bf16 v[176:191], v[200:203], v[152:155], v[176:191]
    v_cvt_pk_bf16_f32 v160, v112, v113
    v_cvt_pk_bf16_f32 v161, v114, v115
    v_cvt_pk_bf16_f32 v162, v116, v117
    v_cvt_pk_bf16_f32 v163, v118, v119
    s_waitcnt lgkmcnt(4)
    v_mfma_f32_32x32x16_bf16 v[176:191], v[204:207], v[156:159], v[176:191]
    v_cvt_pk_bf16_f32 v164, v120, v121
    v_cvt_pk_bf16_f32 v165, v122, v123
    v_cvt_pk_bf16_f32 v166, v124, v125
    v_cvt_pk_bf16_f32 v167, v126, v127
    s_waitcnt lgkmcnt(3)
    v_mfma_f32_32x32x16_bf16 v[176:191], v[208:211], v[160:163], v[176:191]
    s_nop 1
    v_cvt_pk_bf16_f32 v168, v128, v129
    v_cvt_pk_bf16_f32 v169, v130, v131
    v_cvt_pk_bf16_f32 v170, v132, v133
    v_cvt_pk_bf16_f32 v171, v134, v135
    s_waitcnt lgkmcnt(2)
    v_mfma_f32_32x32x16_bf16 v[176:191], v[212:215], v[164:167], v[176:191]
    v_cvt_pk_bf16_f32 v172, v136, v137
    v_cvt_pk_bf16_f32 v173, v138, v139
    v_cvt_pk_bf16_f32 v174, v140, v141
    v_cvt_pk_bf16_f32 v175, v142, v143
    s_waitcnt lgkmcnt(1)
    v_mfma_f32_32x32x16_bf16 v[176:191], v[216:219], v[168:171], v[176:191]
    s_waitcnt lgkmcnt(0)
    s_nop 0
    v_mfma_f32_32x32x16_bf16 v[176:191], v[220:223], v[172:175], v[176:191]
    s_nop 7
    s_nop 3
    v_max3_f32 v32, v176, v177, v178
    v_max3_f32 v33, v179, v180, v181
    v_max3_f32 v32, v32, v182, v183
    v_max3_f32 v33, v33, v184, v185
    v_max3_f32 v32, v32, v186, v187
    v_max3_f32 v33, v33, v188, v189
    v_max3_f32 v32, v32, v190, v191
    v_max_f32 v32, v32, v33
    v_mov_b32 v33, v32
    s_nop 1
    v_permlane32_swap_b32 v32, v33
    v_max_f32 v32, v32, v33
    v_mul_f32 v32, s84, v32
    v_fma_f32 v176, v176, s84, -v32
    v_fma_f32 v177, v177, s84, -v32
    v_fma_f32 v178, v178, s84, -v32
    v_fma_f32 v179, v179, s84, -v32
    v_fma_f32 v180, v180, s84, -v32
    v_fma_f32 v181, v181, s84, -v32
    v_fma_f32 v182, v182, s84, -v32
    v_fma_f32 v183, v183, s84, -v32
    v_fma_f32 v184, v184, s84, -v32
    v_fma_f32 v185, v185, s84, -v32
    v_fma_f32 v186, v186, s84, -v32
    v_fma_f32 v187, v187, s84, -v32
    v_fma_f32 v188, v188, s84, -v32
    v_fma_f32 v189, v189, s84, -v32
    v_fma_f32 v190, v190, s84, -v32
    v_fma_f32 v191, v191, s84, -v32
    v_exp_f32 v176, v176
    v_exp_f32 v177, v177
    v_exp_f32 v178, v178
    v_exp_f32 v179, v179
    v_exp_f32 v180, v180
    v_exp_f32 v181, v181
    v_exp_f32 v182, v182
    v_exp_f32 v183, v183
    v_exp_f32 v184, v184
    v_exp_f32 v185, v185
    v_exp_f32 v186, v186
    v_exp_f32 v187, v187
    v_exp_f32 v188, v188
    v_exp_f32 v189, v189
    v_exp_f32 v190, v190
    v_exp_f32 v191, v191
    s_barrier
    ds_read_b64_tr_b16 v[40:41], v19 offset:0
    ds_read_b64_tr_b16 v[42:43], v19 offset:2048
    ds_read_b64_tr_b16 v[44:45], v19 offset:4096
    ds_read_b64_tr_b16 v[46:47], v19 offset:6144
    ds_read_b64_tr_b16 v[48:49], v25 offset:0
    ds_read_b64_tr_b16 v[50:51], v25 offset:2048
    ds_read_b64_tr_b16 v[52:53], v25 offset:4096
    ds_read_b64_tr_b16 v[54:55], v25 offset:6144
    ds_read_b64_tr_b16 v[56:57], v26 offset:0
    ds_read_b64_tr_b16 v[58:59], v26 offset:2048
    ds_read_b64_tr_b16 v[60:61], v26 offset:4096
    ds_read_b64_tr_b16 v[62:63], v26 offset:6144
    ds_read_b64_tr_b16 v[64:65], v27 offset:0
    ds_read_b64_tr_b16 v[66:67], v27 offset:2048
    ds_read_b64_tr_b16 v[68:69], v27 offset:4096
    ds_read_b64_tr_b16 v[70:71], v27 offset:6144
    v_add_f32 v32, v176, v177
    v_add_f32 v33, v178, v179
    v_add_f32 v32, v32, v180
    v_add_f32 v33, v33, v181
    v_add_f32 v32, v32, v182
    v_add_f32 v33, v33, v183
    v_add_f32 v32, v32, v184
    v_add_f32 v33, v33, v185
    v_add_f32 v32, v32, v186
    v_add_f32 v33, v33, v187
    v_add_f32 v32, v32, v188
    v_add_f32 v33, v33, v189
    v_add_f32 v32, v32, v190
    v_add_f32 v33, v33, v191
    v_add_f32 v32, v32, v33
    v_mov_b32 v33, v32
    s_nop 1
    v_permlane32_swap_b32 v32, v33
    v_add_f32 v32, v32, v33
    v_rcp_f32 v32, v32
    s_lshl_b32 s71, s64, 4
    s_add_u32 s71, s71, s69
    s_lshl_b32 s71, s71, 5
    s_add_u32 s72, s71, s70
    s_lshl_b32 s76, s72, 13
    s_add_u32 s73, s76, 4096
    v_mul_f32 v176, v176, v32
    v_mul_f32 v177, v177, v32
    v_mul_f32 v178, v178, v32
    v_mul_f32 v179, v179, v32
    v_mul_f32 v180, v180, v32
    v_mul_f32 v181, v181, v32
    v_mul_f32 v182, v182, v32
    v_mul_f32 v183, v183, v32
    v_mul_f32 v184, v184, v32
    v_mul_f32 v185, v185, v32
    v_mul_f32 v186, v186, v32
    v_mul_f32 v187, v187, v32
    v_mul_f32 v188, v188, v32
    v_mul_f32 v189, v189, v32
    v_mul_f32 v190, v190, v32
    v_mul_f32 v191, v191, v32
    v_cvt_pk_bf16_f32 v224, v176, v177
    v_cvt_pk_bf16_f32 v225, v178, v179
    v_cvt_pk_bf16_f32 v226, v180, v181
    v_cvt_pk_bf16_f32 v227, v182, v183
    v_cvt_pk_bf16_f32 v228, v184, v185
    v_cvt_pk_bf16_f32 v229, v186, v187
    v_cvt_pk_bf16_f32 v230, v188, v189
    v_cvt_pk_bf16_f32 v231, v190, v191
    s_waitcnt vmcnt(1)
    s_mov_b32 s31, 0x40000
L_go:
    v_mul_lo_u32 v32, v252, s6
    v_lshrrev_b32 v32, 28, v32
    v_cmp_gt_u32 vcc, 4, v32
    s_cbranch_vccz L_go_x
    buffer_load_dword v252, v254, s[60:63], 0 offen sc1
    s_sub_u32 s31, s31, 1
    s_waitcnt vmcnt(0)
    s_cbranch_scc0 L_go
L_go_x:
    v_readlane_b32 s7, v252, s3
    s_barrier
    s_cmp_eq_u32 s7, s5
    s_cbranch_scc1 L_ofast
    s_waitcnt lgkmcnt(12)
    v_mfma_f32_32x32x16_bf16 v[80:95], v[40:43], v[224:227], 0
    v_mfma_f32_32x32x16_bf16 v[80:95], v[44:47], v[228:231], v[80:95]
    s_waitcnt lgkmcnt(8)
    v_mfma_f32_32x32x16_bf16 v[96:111], v[48:51], v[224:227], 0
    v_mfma_f32_32x32x16_bf16 v[96:111], v[52:55], v[228:231], v[96:111]
    s_waitcnt lgkmcnt(4)
    v_mfma_f32_32x32x16_bf16 v[112:127], v[56:59], v[224:227], 0
    v_mfma_f32_32x32x16_bf16 v[112:127], v[60:63], v[228:231], v[112:127]
    v_cvt_pk_bf16_f32 v144, v80, v81
    v_cvt_pk_bf16_f32 v145, v82, v83
    v_cvt_pk_bf16_f32 v146, v84, v85
    v_cvt_pk_bf16_f32 v147, v86, v87
    buffer_store_dwordx4 v[144:147], v17, s[52:55], s76 offen offset:0 sc1
    ds_read_b64_tr_b16 v[40:41], v240 offset:0
    ds_read_b64_tr_b16 v[42:43], v240 offset:2048
    ds_read_b64_tr_b16 v[44:45], v241 offset:0
    ds_read_b64_tr_b16 v[46:47], v241 offset:2048
    ds_read_b64_tr_b16 v[48:49], v242 offset:0
    ds_read_b64_tr_b16 v[50:51], v242 offset:2048
    ds_read_b64_tr_b16 v[52:53], v243 offset:0
    ds_read_b64_tr_b16 v[54:55], v243 offset:2048
    s_waitcnt lgkmcnt(8)
    v_mfma_f32_32x32x16_bf16 v[128:143], v[64:67], v[224:227], 0
    v_cvt_pk_bf16_f32 v148, v88, v89
    v_cvt_pk_bf16_f32 v149, v90, v91
    v_cvt_pk_bf16_f32 v150, v92, v93
    v_cvt_pk_bf16_f32 v151, v94, v95
    buffer_store_dwordx4 v[148:151], v17, s[52:55], s76 offen offset:1024 sc1
    v_mfma_f32_32x32x16_bf16 v[128:143], v[68:71], v[228:231], v[128:143]
    v_cvt_pk_bf16_f32 v152, v96, v97
    v_cvt_pk_bf16_f32 v153, v98, v99
    v_cvt_pk_bf16_f32 v154, v100, v101
    v_cvt_pk_bf16_f32 v155, v102, v103
    buffer_store_dwordx4 v[152:155], v17, s[52:55], s76 offen offset:2048 sc1
    s_waitcnt lgkmcnt(6)
    v_mfma_f32_32x32x16_bf16 v[176:191], v[40:43], v[144:147], 0
    ds_read_b64_tr_b16 v[56:57], v240 offset:4096
    ds_read_b64_tr_b16 v[58:59], v240 offset:6144
    ds_read_b64_tr_b16 v[60:61], v241 offset:4096
    v_cvt_pk_bf16_f32 v156, v104, v105
    v_cvt_pk_bf16_f32 v157, v106, v107
    v_cvt_pk_bf16_f32 v158, v108, v109
    v_cvt_pk_bf16_f32 v159, v110, v111
    buffer_store_dwordx4 v[156:159], v17, s[52:55], s76 offen offset:3072 sc1
    s_waitcnt lgkmcnt(7)
    v_mfma_f32_32x32x16_bf16 v[192:207], v[44:47], v[144:147], 0
    ds_read_b64_tr_b16 v[62:63], v241 offset:6144
    ds_read_b64_tr_b16 v[64:65], v242 offset:4096
    ds_read_b64_tr_b16 v[66:67], v242 offset:6144
    s_waitcnt lgkmcnt(8)
    v_mfma_f32_32x32x16_bf16 v[208:223], v[48:51], v[144:147], 0
    ds_read_b64_tr_b16 v[68:69], v243 offset:4096
    ds_read_b64_tr_b16 v[70:71], v243 offset:6144
    v_cvt_pk_bf16_f32 v160, v112, v113
    v_cvt_pk_bf16_f32 v161, v114, v115
    v_cvt_pk_bf16_f32 v162, v116, v117
    v_cvt_pk_bf16_f32 v163, v118, v119
    buffer_store_dwordx4 v[160:163], v17, s[52:55], s73 offen offset:0 sc1
    s_waitcnt lgkmcnt(8)
    v_mfma_f32_32x32x16_bf16 v[224:239], v[52:55], v[144:147], 0
    s_waitcnt lgkmcnt(6)
    v_mfma_f32_32x32x16_bf16 v[176:191], v[56:59], v[148:151], v[176:191]
    ds_read_b64_tr_b16 v[40:41], v240 offset:8192
    ds_read_b64_tr_b16 v[42:43], v240 offset:10240
    ds_read_b64_tr_b16 v[44:45], v241 offset:8192
    v_cvt_pk_bf16_f32 v164, v120, v121
    v_cvt_pk_bf16_f32 v165, v122, v123
    v_cvt_pk_bf16_f32 v166, v124, v125
    v_cvt_pk_bf16_f32 v167, v126, v127
    buffer_store_dwordx4 v[164:167], v17, s[52:55], s73 offen offset:1024 sc1
    s_waitcnt lgkmcnt(7)
    v_mfma_f32_32x32x16_bf16 v[192:207], v[60:63], v[148:151], v[192:207]
    ds_read_b64_tr_b16 v[46:47], v241 offset:10240
    ds_read_b64_tr_b16 v[48:49], v242 offset:8192
    ds_read_b64_tr_b16 v[50:51], v242 offset:10240
    s_waitcnt lgkmcnt(8)
    v_mfma_f32_32x32x16_bf16 v[208:223], v[64:67], v[148:151], v[208:223]
    ds_read_b64_tr_b16 v[52:53], v243 offset:8192
    ds_read_b64_tr_b16 v[54:55], v243 offset:10240
    v_cvt_pk_bf16_f32 v168, v128, v129
    v_cvt_pk_bf16_f32 v169, v130, v131
    v_cvt_pk_bf16_f32 v170, v132, v133
    v_cvt_pk_bf16_f32 v171, v134, v135
    buffer_store_dwordx4 v[168:171], v17, s[52:55], s73 offen offset:2048 sc1
    s_waitcnt lgkmcnt(8)
    v_mfma_f32_32x32x16_bf16 v[224:239], v[68:71], v[148:151], v[224:239]
    s_waitcnt lgkmcnt(6)
    v_mfma_f32_32x32x16_bf16 v[176:191], v[40:43], v[152:155], v[176:191]
    ds_read_b64_tr_b16 v[56:57], v240 offset:12288
    ds_read_b64_tr_b16 v[58:59], v240 offset:14336
    ds_read_b64_tr_b16 v[60:61], v241 offset:12288
    v_cvt_pk_bf16_f32 v172, v136, v137
    v_cvt_pk_bf16_f32 v173, v138, v139
    v_cvt_pk_bf16_f32 v174, v140, v141
    v_cvt_pk_bf16_f32 v175, v142, v143
    buffer_store_dwordx4 v[172:175], v17, s[52:55], s73 offen offset:3072 sc1
    s_waitcnt lgkmcnt(7)
    v_mfma_f32_32x32x16_bf16 v[192:207], v[44:47], v[152:155], v[192:207]
    ds_read_b64_tr_b16 v[62:63], v241 offset:14336
    ds_read_b64_tr_b16 v[64:65], v242 offset:12288
    ds_read_b64_tr_b16 v[66:67], v242 offset:14336
    s_waitcnt lgkmcnt(8)
    v_mfma_f32_32x32x16_bf16 v[208:223], v[48:51], v[152:155], v[208:223]
    ds_read_b64_tr_b16 v[68:69], v243 offset:12288
    ds_read_b64_tr_b16 v[70:71], v243 offset:14336
    s_waitcnt lgkmcnt(8)
    v_mfma_f32_32x32x16_bf16 v[224:239], v[52:55], v[152:155], v[224:239]
    s_waitcnt lgkmcnt(6)
    v_mfma_f32_32x32x16_bf16 v[176:191], v[56:59], v[156:159], v[176:191]
    ds_read_b64_tr_b16 v[40:41], v240 offset:16384
    ds_read_b64_tr_b16 v[42:43], v240 offset:18432
    ds_read_b64_tr_b16 v[44:45], v241 offset:16384
    s_waitcnt lgkmcnt(7)
    v_mfma_f32_32x32x16_bf16 v[192:207], v[60:63], v[156:159], v[192:207]
    ds_read_b64_tr_b16 v[46:47], v241 offset:18432
    ds_read_b64_tr_b16 v[48:49], v242 offset:16384
    ds_read_b64_tr_b16 v[50:51], v242 offset:18432
    s_waitcnt lgkmcnt(8)
    v_mfma_f32_32x32x16_bf16 v[208:223], v[64:67], v[156:159], v[208:223]
    ds_read_b64_tr_b16 v[52:53], v243 offset:16384
    ds_read_b64_tr_b16 v[54:55], v243 offset:18432
    s_waitcnt lgkmcnt(8)
    v_mfma_f32_32x32x16_bf16 v[224:239], v[68:71], v[156:159], v[224:239]
    s_waitcnt vmcnt(0)
    s_mov_b64 exec, 15
    buffer_store_dword v249, v244, s[52:55], s79 offen sc1
    s_mov_b64 exec, -1
    s_branch L_odone
L_ofast:
    s_waitcnt lgkmcnt(12)
    v_mfma_f32_32x32x16_bf16 v[80:95], v[40:43], v[224:227], 0
    v_mfma_f32_32x32x16_bf16 v[80:95], v[44:47], v[228:231], v[80:95]
    s_waitcnt lgkmcnt(8)
    v_mfma_f32_32x32x16_bf16 v[96:111], v[48:51], v[224:227], 0
    v_mfma_f32_32x32x16_bf16 v[96:111], v[52:55], v[228:231], v[96:111]
    s_waitcnt lgkmcnt(4)
    v_mfma_f32_32x32x16_bf16 v[112:127], v[56:59], v[224:227], 0
    v_mfma_f32_32x32x16_bf16 v[112:127], v[60:63], v[228:231], v[112:127]
    v_cvt_pk_bf16_f32 v144, v80, v81
    v_cvt_pk_bf16_f32 v145, v82, v83
    v_cvt_pk_bf16_f32 v146, v84, v85
    v_cvt_pk_bf16_f32 v147, v86, v87
    buffer_store_dwordx4 v[144:147], v17, s[52:55], s76 offen offset:0
    ds_read_b64_tr_b16 v[40:41], v240 offset:0
    ds_read_b64_tr_b16 v[42:43], v240 offset:2048
    ds_read_b64_tr_b16 v[44:45], v241 offset:0
    ds_read_b64_tr_b16 v[46:47], v241 offset:2048
    ds_read_b64_tr_b16 v[48:49], v242 offset:0
    ds_read_b64_tr_b16 v[50:51], v242 offset:2048
    ds_read_b64_tr_b16 v[52:53], v243 offset:0
    ds_read_b64_tr_b16 v[54:55], v243 offset:2048
    s_waitcnt lgkmcnt(8)
    v_mfma_f32_32x32x16_bf16 v[128:143], v[64:67], v[224:227], 0
    v_cvt_pk_bf16_f32 v148, v88, v89
    v_cvt_pk_bf16_f32 v149, v90, v91
    v_cvt_pk_bf16_f32 v150, v92, v93
    v_cvt_pk_bf16_f32 v151, v94, v95
    buffer_store_dwordx4 v[148:151], v17, s[52:55], s76 offen offset:1024
    v_mfma_f32_32x32x16_bf16 v[128:143], v[68:71], v[228:231], v[128:143]
    v_cvt_pk_bf16_f32 v152, v96, v97
    v_cvt_pk_bf16_f32 v153, v98, v99
    v_cvt_pk_bf16_f32 v154, v100, v101
    v_cvt_pk_bf16_f32 v155, v102, v103
    buffer_store_dwordx4 v[152:155], v17, s[52:55], s76 offen offset:2048
    s_waitcnt lgkmcnt(6)
    v_mfma_f32_32x32x16_bf16 v[176:191], v[40:43], v[144:147], 0
    ds_read_b64_tr_b16 v[56:57], v240 offset:4096
    ds_read_b64_tr_b16 v[58:59], v240 offset:6144
    ds_read_b64_tr_b16 v[60:61], v241 offset:4096
    v_cvt_pk_bf16_f32 v156, v104, v105
    v_cvt_pk_bf16_f32 v157, v106, v107
    v_cvt_pk_bf16_f32 v158, v108, v109
    v_cvt_pk_bf16_f32 v159, v110, v111
    buffer_store_dwordx4 v[156:159], v17, s[52:55], s76 offen offset:3072
    s_waitcnt lgkmcnt(7)
    v_mfma_f32_32x32x16_bf16 v[192:207], v[44:47], v[144:147], 0
    ds_read_b64_tr_b16 v[62:63], v241 offset:6144
    ds_read_b64_tr_b16 v[64:65], v242 offset:4096
    ds_read_b64_tr_b16 v[66:67], v242 offset:6144
    s_waitcnt lgkmcnt(8)
    v_mfma_f32_32x32x16_bf16 v[208:223], v[48:51], v[144:147], 0
    ds_read_b64_tr_b16 v[68:69], v243 offset:4096
    ds_read_b64_tr_b16 v[70:71], v243 offset:6144
    v_cvt_pk_bf16_f32 v160, v112, v113
    v_cvt_pk_bf16_f32 v161, v114, v115
    v_cvt_pk_bf16_f32 v162, v116, v117
    v_cvt_pk_bf16_f32 v163, v118, v119
    buffer_store_dwordx4 v[160:163], v17, s[52:55], s73 offen offset:0
    s_waitcnt lgkmcnt(8)
    v_mfma_f32_32x32x16_bf16 v[224:239], v[52:55], v[144:147], 0
    s_waitcnt lgkmcnt(6)
    v_mfma_f32_32x32x16_bf16 v[176:191], v[56:59], v[148:151], v[176:191]
    ds_read_b64_tr_b16 v[40:41], v240 offset:8192
    ds_read_b64_tr_b16 v[42:43], v240 offset:10240
    ds_read_b64_tr_b16 v[44:45], v241 offset:8192
    v_cvt_pk_bf16_f32 v164, v120, v121
    v_cvt_pk_bf16_f32 v165, v122, v123
    v_cvt_pk_bf16_f32 v166, v124, v125
    v_cvt_pk_bf16_f32 v167, v126, v127
    buffer_store_dwordx4 v[164:167], v17, s[52:55], s73 offen offset:1024
    s_waitcnt lgkmcnt(7)
    v_mfma_f32_32x32x16_bf16 v[192:207], v[60:63], v[148:151], v[192:207]
    ds_read_b64_tr_b16 v[46:47], v241 offset:10240
    ds_read_b64_tr_b16 v[48:49], v242 offset:8192
    ds_read_b64_tr_b16 v[50:51], v242 offset:10240
    s_waitcnt lgkmcnt(8)
    v_mfma_f32_32x32x16_bf16 v[208:223], v[64:67], v[148:151], v[208:223]
    ds_read_b64_tr_b16 v[52:53], v243 offset:8192
    ds_read_b64_tr_b16 v[54:55], v243 offset:10240
    v_cvt_pk_bf16_f32 v168, v128, v129
    v_cvt_pk_bf16_f32 v169, v130, v131
    v_cvt_pk_bf16_f32 v170, v132, v133
    v_cvt_pk_bf16_f32 v171, v134, v135
    buffer_store_dwordx4 v[168:171], v17, s[52:55], s73 offen offset:2048
    s_waitcnt lgkmcnt(8)
    v_mfma_f32_32x32x16_bf16 v[224:239], v[68:71], v[148:151], v[224:239]
    s_waitcnt lgkmcnt(6)
    v_mfma_f32_32x32x16_bf16 v[176:191], v[40:43], v[152:155], v[176:191]
    ds_read_b64_tr_b16 v[56:57], v240 offset:12288
    ds_read_b64_tr_b16 v[58:59], v240 offset:14336
    ds_read_b64_tr_b16 v[60:61], v241 offset:12288
    v_cvt_pk_bf16_f32 v172, v136, v137
    v_cvt_pk_bf16_f32 v173, v138, v139
    v_cvt_pk_bf16_f32 v174, v140, v141
    v_cvt_pk_bf16_f32 v175, v142, v143
    buffer_store_dwordx4 v[172:175], v17, s[52:55], s73 offen offset:3072
    s_waitcnt lgkmcnt(7)
    v_mfma_f32_32x32x16_bf16 v[192:207], v[44:47], v[152:155], v[192:207]
    ds_read_b64_tr_b16 v[62:63], v241 offset:14336
    ds_read_b64_tr_b16 v[64:65], v242 offset:12288
    ds_read_b64_tr_b16 v[66:67], v242 offset:14336
    s_waitcnt lgkmcnt(8)
    v_mfma_f32_32x32x16_bf16 v[208:223], v[48:51], v[152:155], v[208:223]
    ds_read_b64_tr_b16 v[68:69], v243 offset:12288
    ds_read_b64_tr_b16 v[70:71], v243 offset:14336
    s_waitcnt lgkmcnt(8)
    v_mfma_f32_32x32x16_bf16 v[224:239], v[52:55], v[152:155], v[224:239]
    s_waitcnt lgkmcnt(6)
    v_mfma_f32_32x32x16_bf16 v[176:191], v[56:59], v[156:159], v[176:191]
    ds_read_b64_tr_b16 v[40:41], v240 offset:16384
    ds_read_b64_tr_b16 v[42:43], v240 offset:18432
    ds_read_b64_tr_b16 v[44:45], v241 offset:16384
    s_waitcnt lgkmcnt(7)
    v_mfma_f32_32x32x16_bf16 v[192:207], v[60:63], v[156:159], v[192:207]
    ds_read_b64_tr_b16 v[46:47], v241 offset:18432
    ds_read_b64_tr_b16 v[48:49], v242 offset:16384
    ds_read_b64_tr_b16 v[50:51], v242 offset:18432
    s_waitcnt lgkmcnt(8)
    v_mfma_f32_32x32x16_bf16 v[208:223], v[64:67], v[156:159], v[208:223]
    ds_read_b64_tr_b16 v[52:53], v243 offset:16384
    ds_read_b64_tr_b16 v[54:55], v243 offset:18432
    s_waitcnt lgkmcnt(8)
    v_mfma_f32_32x32x16_bf16 v[224:239], v[68:71], v[156:159], v[224:239]
    s_waitcnt vmcnt(0)
    s_mov_b64 exec, 15
    buffer_store_dword v249, v244, s[52:55], s79 offen
    s_mov_b64 exec, -1
L_odone:
    s_and_b32 s76, s76, 0xffff9fff
    s_lshl_b32 s71, s15, 13
    s_add_u32 s8, s71, s76
    s_add_u32 s9, s8, 4096
    s_lshl_b32 s71, s16, 13
    s_add_u32 s10, s71, s76
    s_add_u32 s11, s10, 4096
    s_lshl_b32 s71, s17, 13
    s_add_u32 s12, s71, s76
    s_add_u32 s13, s12, 4096
    s_waitcnt lgkmcnt(6)
    v_mfma_f32_32x32x16_bf16 v[176:191], v[40:43], v[160:163], v[176:191]
    ds_read_b64_tr_b16 v[56:57], v240 offset:20480
    ds_read_b64_tr_b16 v[58:59], v240 offset:22528
    ds_read_b64_tr_b16 v[60:61], v241 offset:20480
    s_waitcnt lgkmcnt(7)
    v_mfma_f32_32x32x16_bf16 v[192:207], v[44:47], v[160:163], v[192:207]
    ds_read_b64_tr_b16 v[62:63], v241 offset:22528
    ds_read_b64_tr_b16 v[64:65], v242 offset:20480
    ds_read_b64_tr_b16 v[66:67], v242 offset:22528
    s_waitcnt lgkmcnt(8)
    v_mfma_f32_32x32x16_bf16 v[208:223], v[48:51], v[160:163], v[208:223]
    ds_read_b64_tr_b16 v[68:69], v243 offset:20480
    ds_read_b64_tr_b16 v[70:71], v243 offset:22528
    s_waitcnt lgkmcnt(8)
    v_mfma_f32_32x32x16_bf16 v[224:239], v[52:55], v[160:163], v[224:239]
    s_waitcnt lgkmcnt(6)
    v_mfma_f32_32x32x16_bf16 v[176:191], v[56:59], v[164:167], v[176:191]
    ds_read_b64_tr_b16 v[40:41], v240 offset:24576
    ds_read_b64_tr_b16 v[42:43], v240 offset:26624
    ds_read_b64_tr_b16 v[44:45], v241 offset:24576
    buffer_load_dword v248, v246, s[52:55], s79 offen sc1
    s_waitcnt lgkmcnt(7)
    v_mfma_f32_32x32x16_bf16 v[192:207], v[60:63], v[164:167], v[192:207]
    ds_read_b64_tr_b16 v[46:47], v241 offset:26624
    ds_read_b64_tr_b16 v[48:49], v242 offset:24576
    ds_read_b64_tr_b16 v[50:51], v242 offset:26624
    s_waitcnt lgkmcnt(8)
    v_mfma_f32_32x32x16_bf16 v[208:223], v[64:67], v[164:167], v[208:223]
    ds_read_b64_tr_b16 v[52:53], v243 offset:24576
    ds_read_b64_tr_b16 v[54:55], v243 offset:26624
    s_waitcnt lgkmcnt(8)
    v_mfma_f32_32x32x16_bf16 v[224:239], v[68:71], v[164:167], v[224:239]
    s_waitcnt vmcnt(0)
    v_cmp_ne_u32 vcc, 1, v248
    s_cbranch_vccz L_s1_x
    s_mov_b32 s31, 0x40000
L_s1:
    buffer_load_dword v248, v246, s[52:55], s79 offen sc1
    s_sub_u32 s31, s31, 1
    s_cbranch_scc1 L_s1_x
    s_waitcnt vmcnt(0)
    v_cmp_ne_u32 vcc, 1, v248
    s_cbranch_vccnz L_s1
L_s1_x:
    buffer_load_dwordx4 v[80:83], v17, s[52:55], s8 offen offset:0 sc1
    buffer_load_dwordx4 v[84:87], v17, s[52:55], s8 offen offset:1024 sc1
    buffer_load_dwordx4 v[88:91], v17, s[52:55], s8 offen offset:2048 sc1
    s_lshl2_add_u32 s71, s64, s67
    s_lshl2_add_u32 s71, s71, s85
    s_lshl_b32 s71, s71, 3
    s_add_u32 s71, s71, s3
    s_lshl2_add_u32 s71, s71, s68
    s_lshl_b32 s71, s71, 13
    s_add_u32 s75, s71, 0x800000
    s_add_u32 s77, s75, 4096
    s_lshr_b32 s71, s3, 1
    s_lshl2_add_u32 s71, s67, s71
    s_lshl_b32 s71, s71, 6
    s_add_u32 s71, s71, s64
    s_lshl2_add_u32 s71, s71, s85
    s_and_b32 s72, s3, 1
    s_lshl1_add_u32 s71, s71, s72
    s_lshl2_add_u32 s71, s71, s68
    s_lshl_b32 s74, s71, 5
    s_mov_b32 s71, 0x3f80
    s_mov_b32 s72, 0x3f800000
    s_waitcnt lgkmcnt(6)
    v_mfma_f32_32x32x16_bf16 v[176:191], v[40:43], v[168:171], v[176:191]
    ds_read_b64_tr_b16 v[56:57], v240 offset:28672
    ds_read_b64_tr_b16 v[58:59], v240 offset:30720
    ds_read_b64_tr_b16 v[60:61], v241 offset:28672
    buffer_load_dwordx4 v[92:95], v17, s[52:55], s8 offen offset:3072 sc1
    s_waitcnt lgkmcnt(7)
    v_mfma_f32_32x32x16_bf16 v[192:207], v[44:47], v[168:171], v[192:207]
    ds_read_b64_tr_b16 v[62:63], v241 offset:30720
    ds_read_b64_tr_b16 v[64:65], v242 offset:28672
    ds_read_b64_tr_b16 v[66:67], v242 offset:30720
    s_waitcnt lgkmcnt(8)
    v_mfma_f32_32x32x16_bf16 v[208:223], v[48:51], v[168:171], v[208:223]
    ds_read_b64_tr_b16 v[68:69], v243 offset:28672
    ds_read_b64_tr_b16 v[70:71], v243 offset:30720
    buffer_load_dwordx4 v[96:99], v17, s[52:55], s9 offen offset:0 sc1
    s_waitcnt lgkmcnt(8)
    v_mfma_f32_32x32x16_bf16 v[224:239], v[52:55], v[168:171], v[224:239]
    s_barrier
    s_waitcnt lgkmcnt(6)
    v_mfma_f32_32x32x16_bf16 v[176:191], v[56:59], v[172:175], v[176:191]
    v_add_u32 v240, 0xffff0000, v240
    ds_read_b64_tr_b16 v[40:41], v240 offset:0
    ds_read_b64_tr_b16 v[42:43], v240 offset:2048
    buffer_load_dwordx4 v[100:103], v17, s[52:55], s9 offen offset:1024 sc1
    s_waitcnt lgkmcnt(6)
    v_mfma_f32_32x32x16_bf16 v[192:207], v[60:63], v[172:175], v[192:207]
    v_add_u32 v241, 0xffff0000, v241
    ds_read_b64_tr_b16 v[44:45], v241 offset:0
    ds_read_b64_tr_b16 v[46:47], v241 offset:2048
    s_waitcnt lgkmcnt(6)
    v_mfma_f32_32x32x16_bf16 v[208:223], v[64:67], v[172:175], v[208:223]
    v_add_u32 v242, 0xffff0000, v242
    ds_read_b64_tr_b16 v[48:49], v242 offset:0
    ds_read_b64_tr_b16 v[50:51], v242 offset:2048
    buffer_load_dwordx4 v[104:107], v17, s[52:55], s9 offen offset:2048 sc1
    s_waitcnt lgkmcnt(6)
    v_mfma_f32_32x32x16_bf16 v[224:239], v[68:71], v[172:175], v[224:239]
    v_add_u32 v243, 0xffff0000, v243
    ds_read_b64_tr_b16 v[52:53], v243 offset:0
    ds_read_b64_tr_b16 v[54:55], v243 offset:2048
    s_waitcnt vmcnt(6) lgkmcnt(6)
    v_mfma_f32_32x32x16_bf16 v[176:191], v[40:43], v[80:83], v[176:191]
    ds_read_b64_tr_b16 v[56:57], v240 offset:4096
    ds_read_b64_tr_b16 v[58:59], v240 offset:6144
    ds_read_b64_tr_b16 v[60:61], v241 offset:4096
    buffer_load_dwordx4 v[108:111], v17, s[52:55], s9 offen offset:3072 sc1
    s_waitcnt lgkmcnt(7)
    v_mfma_f32_32x32x16_bf16 v[192:207], v[44:47], v[80:83], v[192:207]
    ds_read_b64_tr_b16 v[62:63], v241 offset:6144
    ds_read_b64_tr_b16 v[64:65], v242 offset:4096
    ds_read_b64_tr_b16 v[66:67], v242 offset:6144
    s_waitcnt lgkmcnt(8)
    v_mfma_f32_32x32x16_bf16 v[208:223], v[48:51], v[80:83], v[208:223]
    ds_read_b64_tr_b16 v[68:69], v243 offset:4096
    ds_read_b64_tr_b16 v[70:71], v243 offset:6144
    buffer_load_dwordx4 v[112:115], v17, s[52:55], s10 offen offset:0 sc1
    s_waitcnt lgkmcnt(8)
    v_mfma_f32_32x32x16_bf16 v[224:239], v[52:55], v[80:83], v[224:239]
    s_waitcnt vmcnt(7) lgkmcnt(6)
    v_mfma_f32_32x32x16_bf16 v[176:191], v[56:59], v[84:87], v[176:191]
    ds_read_b64_tr_b16 v[40:41], v240 offset:8192
    ds_read_b64_tr_b16 v[42:43], v240 offset:10240
    ds_read_b64_tr_b16 v[44:45], v241 offset:8192
    buffer_load_dwordx4 v[116:119], v17, s[52:55], s10 offen offset:1024 sc1
    s_waitcnt lgkmcnt(7)
    v_mfma_f32_32x32x16_bf16 v[192:207], v[60:63], v[84:87], v[192:207]
    ds_read_b64_tr_b16 v[46:47], v241 offset:10240
    ds_read_b64_tr_b16 v[48:49], v242 offset:8192
    ds_read_b64_tr_b16 v[50:51], v242 offset:10240
    s_waitcnt lgkmcnt(8)
    v_mfma_f32_32x32x16_bf16 v[208:223], v[64:67], v[84:87], v[208:223]
    ds_read_b64_tr_b16 v[52:53], v243 offset:8192
    ds_read_b64_tr_b16 v[54:55], v243 offset:10240
    buffer_load_dwordx4 v[120:123], v17, s[52:55], s10 offen offset:2048 sc1
    s_waitcnt lgkmcnt(8)
    v_mfma_f32_32x32x16_bf16 v[224:239], v[68:71], v[84:87], v[224:239]
    s_waitcnt vmcnt(8) lgkmcnt(6)
    v_mfma_f32_32x32x16_bf16 v[176:191], v[40:43], v[88:91], v[176:191]
    ds_read_b64_tr_b16 v[56:57], v240 offset:12288
    ds_read_b64_tr_b16 v[58:59], v240 offset:14336
    ds_read_b64_tr_b16 v[60:61], v241 offset:12288
    buffer_load_dwordx4 v[124:127], v17, s[52:55], s10 offen offset:3072 sc1
    s_waitcnt lgkmcnt(7)
    v_mfma_f32_32x32x16_bf16 v[192:207], v[44:47], v[88:91], v[192:207]
    ds_read_b64_tr_b16 v[62:63], v241 offset:14336
    ds_read_b64_tr_b16 v[64:65], v242 offset:12288
    ds_read_b64_tr_b16 v[66:67], v242 offset:14336
    s_waitcnt lgkmcnt(8)
    v_mfma_f32_32x32x16_bf16 v[208:223], v[48:51], v[88:91], v[208:223]
    ds_read_b64_tr_b16 v[68:69], v243 offset:12288
    ds_read_b64_tr_b16 v[70:71], v243 offset:14336
    buffer_load_dwordx4 v[128:131], v17, s[52:55], s11 offen offset:0 sc1
    s_waitcnt lgkmcnt(8)
    v_mfma_f32_32x32x16_bf16 v[224:239], v[52:55], v[88:91], v[224:239]
    s_waitcnt vmcnt(9) lgkmcnt(6)
    v_mfma_f32_32x32x16_bf16 v[176:191], v[56:59], v[92:95], v[176:191]
    ds_read_b64_tr_b16 v[40:41], v240 offset:16384
    ds_read_b64_tr_b16 v[42:43], v240 offset:18432
    ds_read_b64_tr_b16 v[44:45], v241 offset:16384
    buffer_load_dwordx4 v[132:135], v17, s[52:55], s11 offen offset:1024 sc1
    s_waitcnt lgkmcnt(7)
    v_mfma_f32_32x32x16_bf16 v[192:207], v[60:63], v[92:95], v[192:207]
    ds_read_b64_tr_b16 v[46:47], v241 offset:18432
    ds_read_b64_tr_b16 v[48:49], v242 offset:16384
    ds_read_b64_tr_b16 v[50:51], v242 offset:18432
    s_waitcnt lgkmcnt(8)
    v_mfma_f32_32x32x16_bf16 v[208:223], v[64:67], v[92:95], v[208:223]
    ds_read_b64_tr_b16 v[52:53], v243 offset:16384
    ds_read_b64_tr_b16 v[54:55], v243 offset:18432
    buffer_load_dwordx4 v[136:139], v17, s[52:55], s11 offen offset:2048 sc1
    s_waitcnt lgkmcnt(8)
    v_mfma_f32_32x32x16_bf16 v[224:239], v[68:71], v[92:95], v[224:239]
    s_waitcnt vmcnt(10) lgkmcnt(6)
    v_mfma_f32_32x32x16_bf16 v[176:191], v[40:43], v[96:99], v[176:191]
    ds_read_b64_tr_b16 v[56:57], v240 offset:20480
    ds_read_b64_tr_b16 v[58:59], v240 offset:22528
    ds_read_b64_tr_b16 v[60:61], v241 offset:20480
    buffer_load_dwordx4 v[140:143], v17, s[52:55], s11 offen offset:3072 sc1
    s_waitcnt lgkmcnt(7)
    v_mfma_f32_32x32x16_bf16 v[192:207], v[44:47], v[96:99], v[192:207]
    ds_read_b64_tr_b16 v[62:63], v241 offset:22528
    ds_read_b64_tr_b16 v[64:65], v242 offset:20480
    ds_read_b64_tr_b16 v[66:67], v242 offset:22528
    s_waitcnt lgkmcnt(8)
    v_mfma_f32_32x32x16_bf16 v[208:223], v[48:51], v[96:99], v[208:223]
    ds_read_b64_tr_b16 v[68:69], v243 offset:20480
    ds_read_b64_tr_b16 v[70:71], v243 offset:22528
    buffer_load_dwordx4 v[144:147], v17, s[52:55], s12 offen offset:0 sc1
    s_waitcnt lgkmcnt(8)
    v_mfma_f32_32x32x16_bf16 v[224:239], v[52:55], v[96:99], v[224:239]
    s_waitcnt vmcnt(11) lgkmcnt(6)
    v_mfma_f32_32x32x16_bf16 v[176:191], v[56:59], v[100:103], v[176:191]
    ds_read_b64_tr_b16 v[40:41], v240 offset:24576
    ds_read_b64_tr_b16 v[42:43], v240 offset:26624
    ds_read_b64_tr_b16 v[44:45], v241 offset:24576
    buffer_load_dwordx4 v[148:151], v17, s[52:55], s12 offen offset:1024 sc1
    s_waitcnt lgkmcnt(7)
    v_mfma_f32_32x32x16_bf16 v[192:207], v[60:63], v[100:103], v[192:207]
    ds_read_b64_tr_b16 v[46:47], v241 offset:26624
    ds_read_b64_tr_b16 v[48:49], v242 offset:24576
    ds_read_b64_tr_b16 v[50:51], v242 offset:26624
    s_waitcnt lgkmcnt(8)
    v_mfma_f32_32x32x16_bf16 v[208:223], v[64:67], v[100:103], v[208:223]
    ds_read_b64_tr_b16 v[52:53], v243 offset:24576
    ds_read_b64_tr_b16 v[54:55], v243 offset:26624
    buffer_load_dwordx4 v[152:155], v17, s[52:55], s12 offen offset:2048 sc1
    s_waitcnt lgkmcnt(8)
    v_mfma_f32_32x32x16_bf16 v[224:239], v[68:71], v[100:103], v[224:239]
    s_waitcnt vmcnt(12) lgkmcnt(6)
    v_mfma_f32_32x32x16_bf16 v[176:191], v[40:43], v[104:107], v[176:191]
    ds_read_b64_tr_b16 v[56:57], v240 offset:28672
    ds_read_b64_tr_b16 v[58:59], v240 offset:30720
    ds_read_b64_tr_b16 v[60:61], v241 offset:28672
    buffer_load_dwordx4 v[156:159], v17, s[52:55], s12 offen offset:3072 sc1
    s_waitcnt lgkmcnt(7)
    v_mfma_f32_32x32x16_bf16 v[192:207], v[44:47], v[104:107], v[192:207]
    ds_read_b64_tr_b16 v[62:63], v241 offset:30720
    ds_read_b64_tr_b16 v[64:65], v242 offset:28672
    ds_read_b64_tr_b16 v[66:67], v242 offset:30720
    s_waitcnt lgkmcnt(8)
    v_mfma_f32_32x32x16_bf16 v[208:223], v[48:51], v[104:107], v[208:223]
    ds_read_b64_tr_b16 v[68:69], v243 offset:28672
    ds_read_b64_tr_b16 v[70:71], v243 offset:30720
    s_waitcnt lgkmcnt(8)
    v_mfma_f32_32x32x16_bf16 v[224:239], v[52:55], v[104:107], v[224:239]
    s_barrier
    s_waitcnt vmcnt(12) lgkmcnt(6)
    v_mfma_f32_32x32x16_bf16 v[176:191], v[56:59], v[108:111], v[176:191]
    v_add_u32 v240, 0x8000, v240
    ds_read_b64_tr_b16 v[40:41], v240 offset:0
    ds_read_b64_tr_b16 v[42:43], v240 offset:2048
    buffer_load_dwordx4 v[160:163], v17, s[52:55], s13 offen offset:0 sc1
    s_waitcnt lgkmcnt(6)
    v_mfma_f32_32x32x16_bf16 v[192:207], v[60:63], v[108:111], v[192:207]
    v_add_u32 v241, 0x8000, v241
    ds_read_b64_tr_b16 v[44:45], v241 offset:0
    ds_read_b64_tr_b16 v[46:47], v241 offset:2048
    s_waitcnt lgkmcnt(6)
    v_mfma_f32_32x32x16_bf16 v[208:223], v[64:67], v[108:111], v[208:223]
    v_add_u32 v242, 0x8000, v242
    ds_read_b64_tr_b16 v[48:49], v242 offset:0
    ds_read_b64_tr_b16 v[50:51], v242 offset:2048
    s_waitcnt lgkmcnt(6)
    v_mfma_f32_32x32x16_bf16 v[224:239], v[68:71], v[108:111], v[224:239]
    v_add_u32 v243, 0x8000, v243
    ds_read_b64_tr_b16 v[52:53], v243 offset:0
    ds_read_b64_tr_b16 v[54:55], v243 offset:2048
    s_waitcnt vmcnt(12) lgkmcnt(6)
    v_mfma_f32_32x32x16_bf16 v[176:191], v[40:43], v[112:115], v[176:191]
    ds_read_b64_tr_b16 v[56:57], v240 offset:4096
    ds_read_b64_tr_b16 v[58:59], v240 offset:6144
    ds_read_b64_tr_b16 v[60:61], v241 offset:4096
    buffer_load_dwordx4 v[164:167], v17, s[52:55], s13 offen offset:1024 sc1
    s_waitcnt lgkmcnt(7)
    v_mfma_f32_32x32x16_bf16 v[192:207], v[44:47], v[112:115], v[192:207]
    ds_read_b64_tr_b16 v[62:63], v241 offset:6144
    ds_read_b64_tr_b16 v[64:65], v242 offset:4096
    ds_read_b64_tr_b16 v[66:67], v242 offset:6144
    s_waitcnt lgkmcnt(8)
    v_mfma_f32_32x32x16_bf16 v[208:223], v[48:51], v[112:115], v[208:223]
    ds_read_b64_tr_b16 v[68:69], v243 offset:4096
    ds_read_b64_tr_b16 v[70:71], v243 offset:6144
    s_waitcnt lgkmcnt(8)
    v_mfma_f32_32x32x16_bf16 v[224:239], v[52:55], v[112:115], v[224:239]
    s_waitcnt vmcnt(12) lgkmcnt(6)
    v_mfma_f32_32x32x16_bf16 v[176:191], v[56:59], v[116:119], v[176:191]
    ds_read_b64_tr_b16 v[40:41], v240 offset:8192
    ds_read_b64_tr_b16 v[42:43], v240 offset:10240
    ds_read_b64_tr_b16 v[44:45], v241 offset:8192
    buffer_load_dwordx4 v[168:171], v17, s[52:55], s13 offen offset:2048 sc1
    s_waitcnt lgkmcnt(7)
    v_mfma_f32_32x32x16_bf16 v[192:207], v[60:63], v[116:119], v[192:207]
    ds_read_b64_tr_b16 v[46:47], v241 offset:10240
    ds_read_b64_tr_b16 v[48:49], v242 offset:8192
    ds_read_b64_tr_b16 v[50:51], v242 offset:10240
    s_waitcnt lgkmcnt(8)
    v_mfma_f32_32x32x16_bf16 v[208:223], v[64:67], v[116:119], v[208:223]
    ds_read_b64_tr_b16 v[52:53], v243 offset:8192
    ds_read_b64_tr_b16 v[54:55], v243 offset:10240
    s_waitcnt lgkmcnt(8)
    v_mfma_f32_32x32x16_bf16 v[224:239], v[68:71], v[116:119], v[224:239]
    s_waitcnt vmcnt(12) lgkmcnt(6)
    v_mfma_f32_32x32x16_bf16 v[176:191], v[40:43], v[120:123], v[176:191]
    ds_read_b64_tr_b16 v[56:57], v240 offset:12288
    ds_read_b64_tr_b16 v[58:59], v240 offset:14336
    ds_read_b64_tr_b16 v[60:61], v241 offset:12288
    buffer_load_dwordx4 v[172:175], v17, s[52:55], s13 offen offset:3072 sc1
    s_waitcnt lgkmcnt(7)
    v_mfma_f32_32x32x16_bf16 v[192:207], v[44:47], v[120:123], v[192:207]
    ds_read_b64_tr_b16 v[62:63], v241 offset:14336
    ds_read_b64_tr_b16 v[64:65], v242 offset:12288
    ds_read_b64_tr_b16 v[66:67], v242 offset:14336
    s_waitcnt lgkmcnt(8)
    v_mfma_f32_32x32x16_bf16 v[208:223], v[48:51], v[120:123], v[208:223]
    ds_read_b64_tr_b16 v[68:69], v243 offset:12288
    ds_read_b64_tr_b16 v[70:71], v243 offset:14336
    s_waitcnt lgkmcnt(8)
    v_mfma_f32_32x32x16_bf16 v[224:239], v[52:55], v[120:123], v[224:239]
    s_waitcnt vmcnt(12) lgkmcnt(6)
    v_mfma_f32_32x32x16_bf16 v[176:191], v[56:59], v[124:127], v[176:191]
    ds_read_b64_tr_b16 v[40:41], v240 offset:16384
    ds_read_b64_tr_b16 v[42:43], v240 offset:18432
    ds_read_b64_tr_b16 v[44:45], v241 offset:16384
    s_waitcnt lgkmcnt(7)
    v_mfma_f32_32x32x16_bf16 v[192:207], v[60:63], v[124:127], v[192:207]
    ds_read_b64_tr_b16 v[46:47], v241 offset:18432
    ds_read_b64_tr_b16 v[48:49], v242 offset:16384
    ds_read_b64_tr_b16 v[50:51], v242 offset:18432
    s_waitcnt lgkmcnt(8)
    v_mfma_f32_32x32x16_bf16 v[208:223], v[64:67], v[124:127], v[208:223]
    ds_read_b64_tr_b16 v[52:53], v243 offset:16384
    ds_read_b64_tr_b16 v[54:55], v243 offset:18432
    s_waitcnt lgkmcnt(8)
    v_mfma_f32_32x32x16_bf16 v[224:239], v[68:71], v[124:127], v[224:239]
    s_waitcnt vmcnt(11) lgkmcnt(6)
    v_mfma_f32_32x32x16_bf16 v[176:191], v[40:43], v[128:131], v[176:191]
    ds_read_b64_tr_b16 v[56:57], v240 offset:20480
    ds_read_b64_tr_b16 v[58:59], v240 offset:22528
    ds_read_b64_tr_b16 v[60:61], v241 offset:20480
    s_waitcnt lgkmcnt(7)
    v_mfma_f32_32x32x16_bf16 v[192:207], v[44:47], v[128:131], v[192:207]
    ds_read_b64_tr_b16 v[62:63], v241 offset:22528
    ds_read_b64_tr_b16 v[64:65], v242 offset:20480
    ds_read_b64_tr_b16 v[66:67], v242 offset:22528
    s_waitcnt lgkmcnt(8)
    v_mfma_f32_32x32x16_bf16 v[208:223], v[48:51], v[128:131], v[208:223]
    ds_read_b64_tr_b16 v[68:69], v243 offset:20480
    ds_read_b64_tr_b16 v[70:71], v243 offset:22528
    s_waitcnt lgkmcnt(8)
    v_mfma_f32_32x32x16_bf16 v[224:239], v[52:55], v[128:131], v[224:239]
    s_waitcnt vmcnt(10) lgkmcnt(6)
    v_mfma_f32_32x32x16_bf16 v[176:191], v[56:59], v[132:135], v[176:191]
    ds_read_b64_tr_b16 v[40:41], v240 offset:24576
    ds_read_b64_tr_b16 v[42:43], v240 offset:26624
    ds_read_b64_tr_b16 v[44:45], v241 offset:24576
    s_waitcnt lgkmcnt(7)
    v_mfma_f32_32x32x16_bf16 v[192:207], v[60:63], v[132:135], v[192:207]
    ds_read_b64_tr_b16 v[46:47], v241 offset:26624
    ds_read_b64_tr_b16 v[48:49], v242 offset:24576
    ds_read_b64_tr_b16 v[50:51], v242 offset:26624
    s_waitcnt lgkmcnt(8)
    v_mfma_f32_32x32x16_bf16 v[208:223], v[64:67], v[132:135], v[208:223]
    ds_read_b64_tr_b16 v[52:53], v243 offset:24576
    ds_read_b64_tr_b16 v[54:55], v243 offset:26624
    s_waitcnt lgkmcnt(8)
    v_mfma_f32_32x32x16_bf16 v[224:239], v[68:71], v[132:135], v[224:239]
    s_waitcnt vmcnt(9) lgkmcnt(6)
    v_mfma_f32_32x32x16_bf16 v[176:191], v[40:43], v[136:139], v[176:191]
    ds_read_b64_tr_b16 v[56:57], v240 offset:28672
    ds_read_b64_tr_b16 v[58:59], v240 offset:30720
    ds_read_b64_tr_b16 v[60:61], v241 offset:28672
    s_waitcnt lgkmcnt(7)
    v_mfma_f32_32x32x16_bf16 v[192:207], v[44:47], v[136:139], v[192:207]
    ds_read_b64_tr_b16 v[62:63], v241 offset:30720
    ds_read_b64_tr_b16 v[64:65], v242 offset:28672
    ds_read_b64_tr_b16 v[66:67], v242 offset:30720
    s_waitcnt lgkmcnt(8)
    v_mfma_f32_32x32x16_bf16 v[208:223], v[48:51], v[136:139], v[208:223]
    ds_read_b64_tr_b16 v[68:69], v243 offset:28672
    ds_read_b64_tr_b16 v[70:71], v243 offset:30720
    s_waitcnt lgkmcnt(8)
    v_mfma_f32_32x32x16_bf16 v[224:239], v[52:55], v[136:139], v[224:239]
    s_barrier
    s_waitcnt vmcnt(8) lgkmcnt(6)
    v_mfma_f32_32x32x16_bf16 v[176:191], v[56:59], v[140:143], v[176:191]
    v_add_u32 v240, 0x10000, v240
    ds_read_b64_tr_b16 v[40:41], v240 offset:0
    ds_read_b64_tr_b16 v[42:43], v240 offset:2048
    s_waitcnt lgkmcnt(6)
    v_mfma_f32_32x32x16_bf16 v[192:207], v[60:63], v[140:143], v[192:207]
    v_add_u32 v241, 0x10000, v241
    ds_read_b64_tr_b16 v[44:45], v240 offset:4096
    ds_read_b64_tr_b16 v[46:47], v240 offset:6144
    s_waitcnt lgkmcnt(6)
    v_mfma_f32_32x32x16_bf16 v[208:223], v[64:67], v[140:143], v[208:223]
    v_add_u32 v242, 0x10000, v242
    ds_read_b64_tr_b16 v[48:49], v240 offset:8192
    ds_read_b64_tr_b16 v[50:51], v240 offset:10240
    s_waitcnt lgkmcnt(6)
    v_mfma_f32_32x32x16_bf16 v[224:239], v[68:71], v[140:143], v[224:239]
    v_add_u32 v243, 0x10000, v243
    ds_read_b64_tr_b16 v[52:53], v240 offset:12288
    ds_read_b64_tr_b16 v[54:55], v240 offset:14336
    s_waitcnt vmcnt(7) lgkmcnt(6)
    v_mfma_f32_32x32x16_bf16 v[176:191], v[40:43], v[144:147], v[176:191]
    ds_read_b64_tr_b16 v[56:57], v240 offset:16384
    ds_read_b64_tr_b16 v[58:59], v240 offset:18432
    ds_read_b64_tr_b16 v[60:61], v240 offset:20480
    s_waitcnt vmcnt(6) lgkmcnt(7)
    v_mfma_f32_32x32x16_bf16 v[176:191], v[44:47], v[148:151], v[176:191]
    ds_read_b64_tr_b16 v[62:63], v240 offset:22528
    ds_read_b64_tr_b16 v[64:65], v240 offset:24576
    ds_read_b64_tr_b16 v[66:67], v240 offset:26624
    s_waitcnt vmcnt(5) lgkmcnt(8)
    v_mfma_f32_32x32x16_bf16 v[176:191], v[48:51], v[152:155], v[176:191]
    ds_read_b64_tr_b16 v[68:69], v240 offset:28672
    ds_read_b64_tr_b16 v[70:71], v240 offset:30720
    s_waitcnt vmcnt(4) lgkmcnt(8)
    v_mfma_f32_32x32x16_bf16 v[176:191], v[52:55], v[156:159], v[176:191]
    s_waitcnt vmcnt(3) lgkmcnt(6)
    v_mfma_f32_32x32x16_bf16 v[176:191], v[56:59], v[160:163], v[176:191]
    ds_read_b64_tr_b16 v[40:41], v241 offset:0
    ds_read_b64_tr_b16 v[42:43], v241 offset:2048
    ds_read_b64_tr_b16 v[44:45], v241 offset:4096
    s_waitcnt vmcnt(2) lgkmcnt(7)
    v_mfma_f32_32x32x16_bf16 v[176:191], v[60:63], v[164:167], v[176:191]
    ds_read_b64_tr_b16 v[46:47], v241 offset:6144
    ds_read_b64_tr_b16 v[48:49], v241 offset:8192
    ds_read_b64_tr_b16 v[50:51], v241 offset:10240
    s_waitcnt vmcnt(1) lgkmcnt(8)
    v_mfma_f32_32x32x16_bf16 v[176:191], v[64:67], v[168:171], v[176:191]
    ds_read_b64_tr_b16 v[52:53], v241 offset:12288
    ds_read_b64_tr_b16 v[54:55], v241 offset:14336
    s_waitcnt vmcnt(0) lgkmcnt(8)
    v_mfma_f32_32x32x16_bf16 v[176:191], v[68:71], v[172:175], v[176:191]
    s_waitcnt lgkmcnt(6)
    v_mfma_f32_32x32x16_bf16 v[192:207], v[40:43], v[144:147], v[192:207]
    ds_read_b64_tr_b16 v[56:57], v241 offset:16384
    ds_read_b64_tr_b16 v[58:59], v241 offset:18432
    ds_read_b64_tr_b16 v[60:61], v241 offset:20480
    s_waitcnt lgkmcnt(7)
    v_mfma_f32_32x32x16_bf16 v[192:207], v[44:47], v[148:151], v[192:207]
    ds_read_b64_tr_b16 v[62:63], v241 offset:22528
    ds_read_b64_tr_b16 v[64:65], v241 offset:24576
    ds_read_b64_tr_b16 v[66:67], v241 offset:26624
    v_cvt_pk_bf16_f32 v80, v176, v177
    v_cvt_pk_bf16_f32 v81, v178, v179
    v_cvt_pk_bf16_f32 v82, v180, v181
    v_cvt_pk_bf16_f32 v83, v182, v183
    buffer_store_dwordx4 v[80:83], v17, s[52:55], s80 offen sc1
    s_add_u32 s80, s80, 8192
    s_waitcnt lgkmcnt(8)
    v_mfma_f32_32x32x16_bf16 v[192:207], v[48:51], v[152:155], v[192:207]
    ds_read_b64_tr_b16 v[68:69], v241 offset:28672
    ds_read_b64_tr_b16 v[70:71], v241 offset:30720
    s_waitcnt lgkmcnt(8)
    v_mfma_f32_32x32x16_bf16 v[192:207], v[52:55], v[156:159], v[192:207]
    v_cvt_pk_bf16_f32 v84, v184, v185
    v_cvt_pk_bf16_f32 v85, v186, v187
    v_cvt_pk_bf16_f32 v86, v188, v189
    v_cvt_pk_bf16_f32 v87, v190, v191
    buffer_store_dwordx4 v[84:87], v17, s[52:55], s80 offen sc1
    s_add_u32 s80, s80, 8192
    s_waitcnt lgkmcnt(6)
    v_mfma_f32_32x32x16_bf16 v[192:207], v[56:59], v[160:163], v[192:207]
    ds_read_b64_tr_b16 v[40:41], v242 offset:0
    ds_read_b64_tr_b16 v[42:43], v242 offset:2048
    ds_read_b64_tr_b16 v[44:45], v242 offset:4096
    s_waitcnt lgkmcnt(7)
    v_mfma_f32_32x32x16_bf16 v[192:207], v[60:63], v[164:167], v[192:207]
    ds_read_b64_tr_b16 v[46:47], v242 offset:6144
    ds_read_b64_tr_b16 v[48:49], v242 offset:8192
    ds_read_b64_tr_b16 v[50:51], v242 offset:10240
    s_waitcnt lgkmcnt(8)
    v_mfma_f32_32x32x16_bf16 v[192:207], v[64:67], v[168:171], v[192:207]
    ds_read_b64_tr_b16 v[52:53], v242 offset:12288
    ds_read_b64_tr_b16 v[54:55], v242 offset:14336
    s_waitcnt lgkmcnt(8)
    v_mfma_f32_32x32x16_bf16 v[192:207], v[68:71], v[172:175], v[192:207]
    s_waitcnt lgkmcnt(6)
    v_mfma_f32_32x32x16_bf16 v[208:223], v[40:43], v[144:147], v[208:223]
    ds_read_b64_tr_b16 v[56:57], v242 offset:16384
    ds_read_b64_tr_b16 v[58:59], v242 offset:18432
    ds_read_b64_tr_b16 v[60:61], v242 offset:20480
    s_waitcnt lgkmcnt(7)
    v_mfma_f32_32x32x16_bf16 v[208:223], v[44:47], v[148:151], v[208:223]
    ds_read_b64_tr_b16 v[62:63], v242 offset:22528
    ds_read_b64_tr_b16 v[64:65], v242 offset:24576
    ds_read_b64_tr_b16 v[66:67], v242 offset:26624
    v_cvt_pk_bf16_f32 v88, v192, v193
    v_cvt_pk_bf16_f32 v89, v194, v195
    v_cvt_pk_bf16_f32 v90, v196, v197
    v_cvt_pk_bf16_f32 v91, v198, v199
    buffer_store_dwordx4 v[88:91], v17, s[52:55], s80 offen sc1
    s_add_u32 s80, s80, 8192
    s_waitcnt lgkmcnt(8)
    v_mfma_f32_32x32x16_bf16 v[208:223], v[48:51], v[152:155], v[208:223]
    ds_read_b64_tr_b16 v[68:69], v242 offset:28672
    ds_read_b64_tr_b16 v[70:71], v242 offset:30720
    s_waitcnt lgkmcnt(8)
    v_mfma_f32_32x32x16_bf16 v[208:223], v[52:55], v[156:159], v[208:223]
    v_cvt_pk_bf16_f32 v92, v200, v201
    v_cvt_pk_bf16_f32 v93, v202, v203
    v_cvt_pk_bf16_f32 v94, v204, v205
    v_cvt_pk_bf16_f32 v95, v206, v207
    buffer_store_dwordx4 v[92:95], v17, s[52:55], s80 offen sc1
    s_add_u32 s80, s80, 8192
    s_waitcnt lgkmcnt(6)
    v_mfma_f32_32x32x16_bf16 v[208:223], v[56:59], v[160:163], v[208:223]
    ds_read_b64_tr_b16 v[40:41], v243 offset:0
    ds_read_b64_tr_b16 v[42:43], v243 offset:2048
    ds_read_b64_tr_b16 v[44:45], v243 offset:4096
    s_waitcnt lgkmcnt(7)
    v_mfma_f32_32x32x16_bf16 v[208:223], v[60:63], v[164:167], v[208:223]
    ds_read_b64_tr_b16 v[46:47], v243 offset:6144
    ds_read_b64_tr_b16 v[48:49], v243 offset:8192
    ds_read_b64_tr_b16 v[50:51], v243 offset:10240
    s_waitcnt lgkmcnt(8)
    v_mfma_f32_32x32x16_bf16 v[208:223], v[64:67], v[168:171], v[208:223]
    ds_read_b64_tr_b16 v[52:53], v243 offset:12288
    ds_read_b64_tr_b16 v[54:55], v243 offset:14336
    s_waitcnt lgkmcnt(8)
    v_mfma_f32_32x32x16_bf16 v[208:223], v[68:71], v[172:175], v[208:223]
    s_waitcnt lgkmcnt(6)
    v_mfma_f32_32x32x16_bf16 v[224:239], v[40:43], v[144:147], v[224:239]
    ds_read_b64_tr_b16 v[56:57], v243 offset:16384
    ds_read_b64_tr_b16 v[58:59], v243 offset:18432
    ds_read_b64_tr_b16 v[60:61], v243 offset:20480
    s_waitcnt lgkmcnt(7)
    v_mfma_f32_32x32x16_bf16 v[224:239], v[44:47], v[148:151], v[224:239]
    ds_read_b64_tr_b16 v[62:63], v243 offset:22528
    ds_read_b64_tr_b16 v[64:65], v243 offset:24576
    ds_read_b64_tr_b16 v[66:67], v243 offset:26624
    v_cvt_pk_bf16_f32 v96, v208, v209
    v_cvt_pk_bf16_f32 v97, v210, v211
    v_cvt_pk_bf16_f32 v98, v212, v213
    v_cvt_pk_bf16_f32 v99, v214, v215
    buffer_store_dwordx4 v[96:99], v17, s[52:55], s80 offen sc1
    s_add_u32 s80, s80, 8192
    s_waitcnt lgkmcnt(8)
    v_mfma_f32_32x32x16_bf16 v[224:239], v[48:51], v[152:155], v[224:239]
    ds_read_b64_tr_b16 v[68:69], v243 offset:28672
    ds_read_b64_tr_b16 v[70:71], v243 offset:30720
    s_waitcnt lgkmcnt(8)
    v_mfma_f32_32x32x16_bf16 v[224:239], v[52:55], v[156:159], v[224:239]
    v_cvt_pk_bf16_f32 v100, v216, v217
    v_cvt_pk_bf16_f32 v101, v218, v219
    v_cvt_pk_bf16_f32 v102, v220, v221
    v_cvt_pk_bf16_f32 v103, v222, v223
    buffer_store_dwordx4 v[100:103], v17, s[52:55], s80 offen sc1
    s_add_u32 s80, s80, 8192
    s_waitcnt lgkmcnt(6)
    v_mfma_f32_32x32x16_bf16 v[224:239], v[56:59], v[160:163], v[224:239]
    s_waitcnt lgkmcnt(4)
    v_mfma_f32_32x32x16_bf16 v[224:239], v[60:63], v[164:167], v[224:239]
    s_waitcnt lgkmcnt(2)
    v_mfma_f32_32x32x16_bf16 v[224:239], v[64:67], v[168:171], v[224:239]
    s_waitcnt lgkmcnt(0)
    v_mfma_f32_32x32x16_bf16 v[224:239], v[68:71], v[172:175], v[224:239]
    s_nop 7
    s_nop 7
    v_cvt_pk_bf16_f32 v104, v224, v225
    v_cvt_pk_bf16_f32 v105, v226, v227
    v_cvt_pk_bf16_f32 v106, v228, v229
    v_cvt_pk_bf16_f32 v107, v230, v231
    buffer_store_dwordx4 v[104:107], v17, s[52:55], s80 offen sc1
    s_add_u32 s80, s80, 8192
    v_cvt_pk_bf16_f32 v108, v232, v233
    v_cvt_pk_bf16_f32 v109, v234, v235
    v_cvt_pk_bf16_f32 v110, v236, v237
    v_cvt_pk_bf16_f32 v111, v238, v239
    buffer_store_dwordx4 v[108:111], v17, s[52:55], s80 offen sc1
    s_waitcnt vmcnt(4)
    s_mov_b64 exec, 1
    buffer_store_dword v249, v245, s[52:55], s79 offen sc1
    s_waitcnt vmcnt(1)
    s_mov_b64 exec, 2
    buffer_store_dword v249, v245, s[52:55], s79 offen sc1
    s_mov_b64 exec, -1
    s_mov_b32 s31, 0x40000
L_s2:
    buffer_load_dword v248, v247, s[52:55], s79 offen sc1
    s_sub_u32 s31, s31, 1
    s_cbranch_scc1 L_s2_x
    s_waitcnt vmcnt(0)
    v_cmp_ne_u32 vcc, 1, v248
    s_cbranch_vccnz L_s2
L_s2_x:
    buffer_load_dwordx4 v[112:115], v17, s[52:55], s75 offen offset:0 sc1
    buffer_load_dwordx4 v[116:119], v17, s[52:55], s75 offen offset:1024 sc1
    buffer_load_dwordx4 v[120:123], v17, s[52:55], s75 offen offset:2048 sc1
    buffer_load_dwordx4 v[124:127], v17, s[52:55], s75 offen offset:3072 sc1
    buffer_load_dwordx4 v[128:131], v17, s[52:55], s77 offen offset:0 sc1
    buffer_load_dwordx4 v[132:135], v17, s[52:55], s77 offen offset:1024 sc1
    buffer_load_dwordx4 v[136:139], v17, s[52:55], s77 offen offset:2048 sc1
    buffer_load_dwordx4 v[140:143], v17, s[52:55], s77 offen offset:3072 sc1
    s_waitcnt vmcnt(7)
    v_lshlrev_b32 v40, 16, v112
    v_and_b32 v41, 0xffff0000, v112
    v_lshlrev_b32 v42, 16, v113
    v_and_b32 v43, 0xffff0000, v113
    v_lshlrev_b32 v44, 16, v114
    v_and_b32 v45, 0xffff0000, v114
    v_lshlrev_b32 v46, 16, v115
    v_and_b32 v47, 0xffff0000, v115
    s_waitcnt vmcnt(6)
    v_dot2_f32_bf16 v40, v116, s71, v40
    v_dot2_f32_bf16 v41, v116, s72, v41
    v_dot2_f32_bf16 v42, v117, s71, v42
    v_dot2_f32_bf16 v43, v117, s72, v43
    v_dot2_f32_bf16 v44, v118, s71, v44
    v_dot2_f32_bf16 v45, v118, s72, v45
    v_dot2_f32_bf16 v46, v119, s71, v46
    v_dot2_f32_bf16 v47, v119, s72, v47
    s_waitcnt vmcnt(5)
    v_dot2_f32_bf16 v40, v120, s71, v40
    v_dot2_f32_bf16 v41, v120, s72, v41
    v_dot2_f32_bf16 v42, v121, s71, v42
    v_dot2_f32_bf16 v43, v121, s72, v43
    v_dot2_f32_bf16 v44, v122, s71, v44
    v_dot2_f32_bf16 v45, v122, s72, v45
    v_dot2_f32_bf16 v46, v123, s71, v46
    v_dot2_f32_bf16 v47, v123, s72, v47
    s_waitcnt vmcnt(4)
    v_dot2_f32_bf16 v40, v124, s71, v40
    v_dot2_f32_bf16 v41, v124, s72, v41
    v_dot2_f32_bf16 v42, v125, s71, v42
    v_dot2_f32_bf16 v43, v125, s72, v43
    v_dot2_f32_bf16 v44, v126, s71, v44
    v_dot2_f32_bf16 v45, v126, s72, v45
    v_dot2_f32_bf16 v46, v127, s71, v46
    v_dot2_f32_bf16 v47, v127, s72, v47
    s_waitcnt vmcnt(3)
    v_dot2_f32_bf16 v40, v128, s71, v40
    v_dot2_f32_bf16 v41, v128, s72, v41
    v_dot2_f32_bf16 v42, v129, s71, v42
    v_dot2_f32_bf16 v43, v129, s72, v43
    v_dot2_f32_bf16 v44, v130, s71, v44
    v_dot2_f32_bf16 v45, v130, s72, v45
    v_dot2_f32_bf16 v46, v131, s71, v46
    v_dot2_f32_bf16 v47, v131, s72, v47
    s_waitcnt vmcnt(2)
    v_dot2_f32_bf16 v40, v132, s71, v40
    v_dot2_f32_bf16 v41, v132, s72, v41
    v_dot2_f32_bf16 v42, v133, s71, v42
    v_dot2_f32_bf16 v43, v133, s72, v43
    v_dot2_f32_bf16 v44, v134, s71, v44
    v_dot2_f32_bf16 v45, v134, s72, v45
    v_dot2_f32_bf16 v46, v135, s71, v46
    v_dot2_f32_bf16 v47, v135, s72, v47
    s_waitcnt vmcnt(1)
    v_dot2_f32_bf16 v40, v136, s71, v40
    v_dot2_f32_bf16 v41, v136, s72, v41
    v_dot2_f32_bf16 v42, v137, s71, v42
    v_dot2_f32_bf16 v43, v137, s72, v43
    v_dot2_f32_bf16 v44, v138, s71, v44
    v_dot2_f32_bf16 v45, v138, s72, v45
    v_dot2_f32_bf16 v46, v139, s71, v46
    v_dot2_f32_bf16 v47, v139, s72, v47
    s_waitcnt vmcnt(0)
    v_dot2_f32_bf16 v40, v140, s71, v40
    v_dot2_f32_bf16 v41, v140, s72, v41
    v_dot2_f32_bf16 v42, v141, s71, v42
    v_dot2_f32_bf16 v43, v141, s72, v43
    v_dot2_f32_bf16 v44, v142, s71, v44
    v_dot2_f32_bf16 v45, v142, s72, v45
    v_dot2_f32_bf16 v46, v143, s71, v46
    v_dot2_f32_bf16 v47, v143, s72, v47
    s_nop 2
    v_cvt_pk_bf16_f32 v144, v40, v41
    v_cvt_pk_bf16_f32 v145, v42, v43
    v_cvt_pk_bf16_f32 v146, v44, v45
    v_cvt_pk_bf16_f32 v147, v46, v47
    buffer_store_dwordx4 v[144:147], v250, s[56:59], s74 offen
L_end:
    s_endpgm
L_helper:
    s_waitcnt lgkmcnt(0)
    s_cmp_eq_u32 s64, 0
    s_mov_b64 s[52:53], s[28:29]
    s_mov_b32 s54, 0x2000000
    s_mov_b32 s55, 0x20000
    s_cselect_b64 s[40:41], s[6:7], s[16:17]
    s_mov_b32 s43, 0x100000
    s_cselect_b32 s42, s43, 0x400000
    s_mov_b32 s43, 0x20000
    s_cselect_b64 s[44:45], s[8:9], s[18:19]
    s_mov_b32 s47, 0x100000
    s_cselect_b32 s46, s47, 0x400000
    s_mov_b32 s47, 0x20000
    s_cselect_b64 s[48:49], s[12:13], s[22:23]
    s_mov_b32 s50, 0x400000
    s_mov_b32 s51, 0x20000
    s_mov_b64 s[60:61], s[26:27]
    s_mov_b32 s62, 0x100
    s_mov_b32 s63, 0x20000
    s_getreg_b32 s5, hwreg(HW_REG_XCC_ID, 0, 3)
    s_lshl_b32 s5, s5, 2
    s_lshl_b32 s5, 1, s5
    v_mov_b32 v253, s5
    s_cmp_lg_u32 s68, 0
    s_cbranch_scc1 L_noann
    buffer_store_dword v2, v1, s[52:55], s73 offen sc1
L_noann:
    s_cmp_eq_u32 s67, 3
    s_cselect_b32 s71, 0, s67
    s_add_u32 s72, s71, 1
    s_cmp_gt_u32 s72, 3
    s_cselect_b32 s14, 3, 0
    s_sub_u32 s72, s72, s14
    s_add_u32 s72, s72, s85
    s_and_b32 s15, s72, 3
    s_add_u32 s72, s71, 2
    s_cmp_gt_u32 s72, 3
    s_cselect_b32 s14, 3, 0
    s_sub_u32 s72, s72, s14
    s_add_u32 s72, s72, s85
    s_and_b32 s16, s72, 3
    s_add_u32 s72, s71, 3
    s_cmp_gt_u32 s72, 3
    s_cselect_b32 s14, 3, 0
    s_sub_u32 s72, s72, s14
    s_add_u32 s72, s72, s85
    s_and_b32 s17, s72, 3
    s_barrier
    s_barrier
    s_cmp_lg_u32 s68, 0
    s_cbranch_scc1 L_noann2
    s_waitcnt vmcnt(0)
    s_mov_b64 exec, 1
    buffer_atomic_add v253, v251, s[60:63], 0 offen sc1
    s_mov_b64 exec, -1
L_noann2:
    s_add_u32 m0, s83, 98304
    s_nop 0
    buffer_load_dwordx4 v12, s[40:43], s77 offen lds
    buffer_load_dwordx4 v13, s[40:43], s77 offen offset:1024 lds
    buffer_load_dwordx4 v14, s[40:43], s77 offen offset:2048 lds
    buffer_load_dwordx4 v15, s[40:43], s77 offen offset:3072 lds
    s_add_u32 s77, s77, 4096
    s_barrier
    s_add_u32 m0, s83, 102400
    s_nop 0
    buffer_load_dwordx4 v12, s[40:43], s77 offen lds
    buffer_load_dwordx4 v13, s[40:43], s77 offen offset:1024 lds
    buffer_load_dwordx4 v14, s[40:43], s77 offen offset:2048 lds
    buffer_load_dwordx4 v15, s[40:43], s77 offen offset:3072 lds
    s_add_u32 s77, s77, 4294963200
    s_barrier
    s_barrier
    s_add_u32 m0, s83, 131072
    s_nop 0
    buffer_load_dwordx4 v16, s[44:47], s84 offen lds
    buffer_load_dwordx4 v16, s[44:47], s84 offen offset:1024 lds
    buffer_load_dwordx4 v16, s[44:47], s84 offen offset:2048 lds
    buffer_load_dwordx4 v16, s[44:47], s84 offen offset:3072 lds
    s_add_u32 s84, s84, 4096
    s_barrier
    s_add_u32 m0, s83, 135168
    s_nop 0
    buffer_load_dwordx4 v16, s[44:47], s84 offen lds
    buffer_load_dwordx4 v16, s[44:47], s84 offen offset:1024 lds
    buffer_load_dwordx4 v16, s[44:47], s84 offen offset:2048 lds
    buffer_load_dwordx4 v16, s[44:47], s84 offen offset:3072 lds
    s_barrier
    s_lshl2_add_u32 s74, s3, s85
    s_lshl_b32 s74, s74, 9
    s_add_u32 s74, s74, s85
    s_lshl_b32 s78, s74, 8
    s_add_u32 m0, s83, 65536
    s_nop 0
    buffer_load_dwordx4 v20, s[48:51], s78 offen offset:0 lds
    buffer_load_dwordx4 v21, s[48:51], s78 offen offset:1024 lds
    buffer_load_dwordx4 v22, s[48:51], s78 offen offset:2048 lds
    buffer_load_dwordx4 v23, s[48:51], s78 offen offset:3072 lds
    s_add_u32 s78, s78, 16384
    s_add_u32 m0, s83, 69632
    s_nop 0
    buffer_load_dwordx4 v20, s[48:51], s78 offen offset:0 lds
    buffer_load_dwordx4 v21, s[48:51], s78 offen offset:1024 lds
    buffer_load_dwordx4 v22, s[48:51], s78 offen offset:2048 lds
    buffer_load_dwordx4 v23, s[48:51], s78 offen offset:3072 lds
    s_barrier
    s_lshl2_add_u32 s74, s3, s15
    s_lshl_b32 s74, s74, 9
    s_add_u32 s74, s74, s85
    s_lshl_b32 s78, s74, 8
    s_add_u32 m0, s83, 0
    s_nop 0
    buffer_load_dwordx4 v20, s[48:51], s78 offen offset:0 lds
    buffer_load_dwordx4 v21, s[48:51], s78 offen offset:1024 lds
    buffer_load_dwordx4 v22, s[48:51], s78 offen offset:2048 lds
    buffer_load_dwordx4 v23, s[48:51], s78 offen offset:3072 lds
    s_add_u32 s78, s78, 16384
    s_add_u32 m0, s83, 4096
    s_nop 0
    buffer_load_dwordx4 v20, s[48:51], s78 offen offset:0 lds
    buffer_load_dwordx4 v21, s[48:51], s78 offen offset:1024 lds
    buffer_load_dwordx4 v22, s[48:51], s78 offen offset:2048 lds
    buffer_load_dwordx4 v23, s[48:51], s78 offen offset:3072 lds
    s_waitcnt vmcnt(24)
    s_barrier
    s_lshl2_add_u32 s74, s3, s16
    s_lshl_b32 s74, s74, 9
    s_add_u32 s74, s74, s85
    s_lshl_b32 s78, s74, 8
    s_add_u32 m0, s83, 32768
    s_nop 0
    buffer_load_dwordx4 v20, s[48:51], s78 offen offset:0 lds
    buffer_load_dwordx4 v21, s[48:51], s78 offen offset:1024 lds
    buffer_load_dwordx4 v22, s[48:51], s78 offen offset:2048 lds
    buffer_load_dwordx4 v23, s[48:51], s78 offen offset:3072 lds
    s_add_u32 s78, s78, 16384
    s_add_u32 m0, s83, 36864
    s_nop 0
    buffer_load_dwordx4 v20, s[48:51], s78 offen offset:0 lds
    buffer_load_dwordx4 v21, s[48:51], s78 offen offset:1024 lds
    buffer_load_dwordx4 v22, s[48:51], s78 offen offset:2048 lds
    buffer_load_dwordx4 v23, s[48:51], s78 offen offset:3072 lds
    s_waitcnt vmcnt(24)
    s_barrier
    s_lshl2_add_u32 s74, s3, s17
    s_lshl_b32 s74, s74, 9
    s_add_u32 s74, s74, s85
    s_lshl_b32 s78, s74, 8
    s_add_u32 m0, s83, 98304
    s_nop 0
    buffer_load_dwordx4 v20, s[48:51], s78 offen offset:0 lds
    buffer_load_dwordx4 v21, s[48:51], s78 offen offset:1024 lds
    buffer_load_dwordx4 v22, s[48:51], s78 offen offset:2048 lds
    buffer_load_dwordx4 v23, s[48:51], s78 offen offset:3072 lds
    s_add_u32 s78, s78, 16384
    s_add_u32 m0, s83, 102400
    s_nop 0
    buffer_load_dwordx4 v20, s[48:51], s78 offen offset:0 lds
    buffer_load_dwordx4 v21, s[48:51], s78 offen offset:1024 lds
    buffer_load_dwordx4 v22, s[48:51], s78 offen offset:2048 lds
    buffer_load_dwordx4 v23, s[48:51], s78 offen offset:3072 lds
    s_waitcnt vmcnt(24)
    s_barrier
    s_waitcnt vmcnt(16)
    s_barrier
    s_waitcnt vmcnt(8)
    s_barrier
    s_waitcnt vmcnt(0)
    s_barrier
    s_endpgm
.section .rodata,"a"
.p2align 6
.amdhsa_kernel concat_heads__gqa_block_cached__mha_block_cached__near_ridge_kernel
  .amdhsa_next_free_vgpr 256
  .amdhsa_next_free_sgpr 102
  .amdhsa_accum_offset 256
  .amdhsa_group_segment_fixed_size 0
  .amdhsa_kernarg_size 104
  .amdhsa_user_sgpr_count 2
  .amdhsa_user_sgpr_kernarg_segment_ptr 1
  .amdhsa_system_sgpr_workgroup_id_x 1
.end_amdhsa_kernel
```
